```python
import torch

def _softmax(x, axis=-1):
    return torch.softmax(x, dim=axis)
def _gelu(x):
    return torch.nn.functional.gelu(x, approximate="tanh")
def _silu(x):
    return torch.nn.functional.silu(x)
def _sigmoid(x):
    return torch.sigmoid(x)
def _layernorm(x, axis=-1, eps=1e-5):
    m = x.mean(dim=axis, keepdim=True)
    v = x.var(dim=axis, keepdim=True, unbiased=False)
    return (x - m) / torch.sqrt(v + eps)
def _scatter_add(tgt, idx, src, axis=0):
    return tgt.clone().index_add_(axis, idx, src)
def _segment_sum(src, seg, n):
    out = torch.zeros((n,) + src.shape[1:], dtype=src.dtype)
    return out.index_add_(0, seg, src)
def _pad(x, pw):
    flat = tuple(v for pair in reversed(pw) for v in pair)
    return torch.nn.functional.pad(x, flat)

kernel_name = 'gated_mix__mha_block__dense_activation_squared_relu__prompt'

def setup_inputs():

    _w = (lambda a: (lambda t: t.to(torch.bfloat16) if t.is_floating_point() else t)(torch.as_tensor(a)))
    def _A_setup():
        B, S, D, H = 1, 2048, 512, 32
        return {
            "x": _w((lambda *s: torch.randn(*s, dtype=torch.bfloat16) * 0.05)(B, S, D)),
            "wqkv": _w((lambda *s: torch.randn(*s, dtype=torch.bfloat16) * 0.8)(D, 3 * D)),
            "wo": _w((lambda *s: torch.randn(*s, dtype=torch.bfloat16) * 0.1)(D, D)),
        }
    _A_in = _A_setup()

    def _B_setup():
        B, S, D, F = 1, 2048, 512, 1376
        return {
            "x": _w((lambda *s: torch.randn(*s, dtype=torch.bfloat16) * 0.05)(B, S, D)),
            "w1": _w((lambda *s: torch.randn(*s, dtype=torch.bfloat16) * 0.1)(D, F)),
            "b1": _w((lambda *s: torch.randn(*s, dtype=torch.bfloat16) * 0.1)(F)),
            "w2": _w((lambda *s: torch.randn(*s, dtype=torch.bfloat16) * 0.1)(F, D)),
            "b2": _w((lambda *s: torch.randn(*s, dtype=torch.bfloat16) * 0.05)(D)),
        }
    _B_in = _B_setup()

    return {
        "A_x": _A_in["x"],
        "A_wqkv": _A_in["wqkv"],
        "A_wo": _A_in["wo"],
        "B_x": _B_in["x"],
        "B_w1": _B_in["w1"],
        "B_b1": _B_in["b1"],
        "B_w2": _B_in["w2"],
        "B_b2": _B_in["b2"],
        "gate_w": _w((lambda *s: torch.randn(*s, dtype=torch.bfloat16) * 0.05)(512) * 16.0),
    }

def reference(A_x, A_wqkv, A_wo, B_x, B_w1, B_b1, B_w2, B_b2, gate_w):
    def _A_ref(x, wqkv, wo):
        B, S, D = x.shape
        H = 32
        Dh = D // H
        qkv = (lambda x, *d: x.permute(*d))((x @ wqkv).reshape(B, S, 3, H, Dh), 2, 0, 3, 1, 4)
        q, k, v = qkv[0], qkv[1], qkv[2]
        scores = torch.einsum("bhqd,bhkd->bhqk", q, k) * (Dh ** -0.5)
        p = _softmax(scores, axis=-1)
        o = torch.einsum("bhqk,bhkd->bhqd", p, v)
        return (lambda x, *d: x.permute(*d))(o, 0, 2, 1, 3).reshape(B, S, D) @ wo

    def _B_ref(x, w1, b1, w2, b2):
        h = torch.einsum("bsd,df->bsf", x, w1) + b1
        zero = torch.zeros_like(h)
        r = torch.where(h > zero, h, zero)
        h = r * r
        out = torch.einsum("bsf,fd->bsd", h, w2) + b2
        return out

    x = A_x
    g = _sigmoid((x * gate_w).sum(-1, keepdims=True))
    a = _A_ref(x, A_wqkv, A_wo)
    b = _B_ref(x, B_w1, B_b1, B_w2, B_b2)
    return g * a + (1 - g) * b
```

```asm
; @launch grid=(256,1,1) block=(768,1,1) lds=163840
.amdgcn_target "amdgcn-amd-amdhsa--gfx950"
.text
.globl gated_mix__mha_block__dense_activation_squared_relu__prompt_kernel
.p2align 8
.type gated_mix__mha_block__dense_activation_squared_relu__prompt_kernel,@function
gated_mix__mha_block__dense_activation_squared_relu__prompt_kernel:
  s_cmp_ge_u32 s2, 256
  s_cbranch_scc1 L_end
  s_load_dwordx4 s[4:7], s[0:1], 0
  s_load_dwordx2 s[8:9], s[0:1], 16
  s_load_dwordx4 s[12:15], s[0:1], 32
  s_load_dwordx4 s[16:19], s[0:1], 48
  s_load_dwordx4 s[20:23], s[0:1], 64
  s_load_dwordx4 s[24:27], s[0:1], 80
  v_lshrrev_b32 v2, 6, v0
  v_and_b32 v1, 63, v0
  v_readfirstlane_b32 s3, v2
  s_getpc_b64 s[52:53]
L_pc0:
  s_sub_u32 s52, s52, L_pc0-gated_mix__mha_block__dense_activation_squared_relu__prompt_kernel
  s_subb_u32 s53, s53, 0
  v_lshlrev_b32 v3, 7, v0
  v_min_u32 v3, L_code_end-gated_mix__mha_block__dense_activation_squared_relu__prompt_kernel-4, v3
  s_cmp_ge_u32 s3, 3
  s_cbranch_scc1 L_pc1
  global_load_dword v31, v3, s[52:53]
L_pc1:
  s_and_b32 s52, s2, 7
  s_lshr_b32 s53, s2, 3
  s_lshr_b32 s54, s52, 2
  s_lshl_b32 s54, s54, 4
  s_lshr_b32 s55, s53, 1
  s_add_u32 s29, s54, s55
  s_and_b32 s54, s52, 3
  s_lshl_b32 s54, s54, 1
  s_and_b32 s55, s53, 1
  s_add_u32 s30, s54, s55
  s_mul_i32 s54, s30, 6
  s_min_u32 s31, s54, 37
  s_lshl_b32 s61, s52, 2
  s_and_b32 s54, s53, 3
  s_add_u32 s61, s61, s54
  s_lshr_b32 s62, s2, 5
  s_waitcnt lgkmcnt(0)
  s_cmp_ge_u32 s3, 8
  s_cbranch_scc1 L_aux
  s_cmp_lt_u32 s3, 4
  s_cbranch_scc1 L_cons
  s_sub_u32 s67, s3, 4
  s_lshl_b32 s54, s29, 16
  s_add_u32 s32, s4, s54
  s_addc_u32 s33, s5, 0
  s_mov_b32 s34, 65536
  s_mov_b32 s35, 0x20000
  v_lshrrev_b32 v2, 3, v1
  s_lshl_b32 s54, s67, 3
  v_add_u32 v2, s54, v2
  v_lshrrev_b32 v3, 4, v1
  s_and_b32 s54, s67, 1
  s_lshl_b32 s54, s54, 2
  v_add_u32 v3, s54, v3
  v_and_b32 v4, 7, v1
  v_xor_b32 v3, v3, v4
  v_lshlrev_b32 v3, 4, v3
  v_lshl_add_u32 v12, v2, 10, v3
  s_lshl_b32 s68, s67, 10
  s_add_u32 m0, s68, 0
  s_movk_i32 s81, 0
  buffer_load_dwordx4 v12, s[32:35], s81 offen lds
  s_add_u32 m0, s68, 8192
  s_movk_i32 s81, 128
  buffer_load_dwordx4 v12, s[32:35], s81 offen lds
  s_add_u32 m0, s68, 16384
  s_movk_i32 s81, 256
  buffer_load_dwordx4 v12, s[32:35], s81 offen lds
  s_mov_b32 s36, s6
  s_mov_b32 s37, s7
  s_mov_b32 s38, 1572864
  s_mov_b32 s39, 0x20000
  v_add_u32 v2, 0, v1
  v_mul_u32_u24 v3, 171, v2
  v_lshrrev_b32 v3, 12, v3
  v_mul_u32_u24 v4, 24, v3
  v_sub_u32 v2, v2, v4
  v_lshrrev_b32 v4, 3, v2
  v_and_b32 v2, 7, v2
  v_bfe_u32 v5, v3, 1, 1
  v_lshlrev_b32 v5, 2, v5
  v_xor_b32 v2, v2, v5
  v_lshlrev_b32 v2, 4, v2
  v_mul_u32_u24 v5, 3072, v3
  v_lshl_add_u32 v5, v4, 10, v5
  v_add_u32 v13, v5, v2
  v_add_u32 v2, 64, v1
  v_mul_u32_u24 v3, 171, v2
  v_lshrrev_b32 v3, 12, v3
  v_mul_u32_u24 v4, 24, v3
  v_sub_u32 v2, v2, v4
  v_lshrrev_b32 v4, 3, v2
  v_and_b32 v2, 7, v2
  v_bfe_u32 v5, v3, 1, 1
  v_lshlrev_b32 v5, 2, v5
  v_xor_b32 v2, v2, v5
  v_lshlrev_b32 v2, 4, v2
  v_mul_u32_u24 v5, 3072, v3
  v_lshl_add_u32 v5, v4, 10, v5
  v_add_u32 v14, v5, v2
  v_add_u32 v2, 128, v1
  v_mul_u32_u24 v3, 171, v2
  v_lshrrev_b32 v3, 12, v3
  v_mul_u32_u24 v4, 24, v3
  v_sub_u32 v2, v2, v4
  v_lshrrev_b32 v4, 3, v2
  v_and_b32 v2, 7, v2
  v_bfe_u32 v5, v3, 1, 1
  v_lshlrev_b32 v5, 2, v5
  v_xor_b32 v2, v2, v5
  v_lshlrev_b32 v2, 4, v2
  v_mul_u32_u24 v5, 3072, v3
  v_lshl_add_u32 v5, v4, 10, v5
  v_add_u32 v15, v5, v2
  s_mul_i32 s69, s67, 3072
  s_add_u32 s69, s69, 0x10000
  s_lshl_b32 s70, s30, 7
  s_mul_i32 s71, s67, 24576
  s_add_u32 s70, s70, s71
  s_add_u32 s82, s70, 0
  s_add_u32 m0, s69, 0
  s_nop 0
  buffer_load_dwordx4 v13, s[36:39], s82 offen lds
  s_add_u32 m0, s69, 1024
  s_nop 0
  buffer_load_dwordx4 v14, s[36:39], s82 offen lds
  s_add_u32 m0, s69, 2048
  s_nop 0
  buffer_load_dwordx4 v15, s[36:39], s82 offen lds
  s_add_u32 s82, s70, 196608
  s_add_u32 m0, s69, 24576
  s_nop 0
  buffer_load_dwordx4 v13, s[36:39], s82 offen lds
  s_add_u32 m0, s69, 25600
  s_nop 0
  buffer_load_dwordx4 v14, s[36:39], s82 offen lds
  s_add_u32 m0, s69, 26624
  s_nop 0
  buffer_load_dwordx4 v15, s[36:39], s82 offen lds
  s_add_u32 s82, s70, 393216
  s_add_u32 m0, s69, 49152
  s_nop 0
  buffer_load_dwordx4 v13, s[36:39], s82 offen lds
  s_add_u32 m0, s69, 50176
  s_nop 0
  buffer_load_dwordx4 v14, s[36:39], s82 offen lds
  s_add_u32 m0, s69, 51200
  s_nop 0
  buffer_load_dwordx4 v15, s[36:39], s82 offen lds
  s_mov_b32 s40, s12
  s_mov_b32 s41, s13
  s_mov_b32 s42, 1409024
  s_mov_b32 s43, 0x20000
  v_add_u32 v2, 0, v1
  v_mul_u32_u24 v3, 171, v2
  v_lshrrev_b32 v3, 12, v3
  v_mul_u32_u24 v4, 24, v3
  v_sub_u32 v2, v2, v4
  v_lshrrev_b32 v4, 3, v2
  v_and_b32 v2, 7, v2
  v_bfe_u32 v5, v3, 1, 1
  v_lshlrev_b32 v5, 2, v5
  v_xor_b32 v2, v2, v5
  v_lshlrev_b32 v2, 4, v2
  v_mul_u32_u24 v5, 2752, v3
  v_lshl_add_u32 v5, v4, 7, v5
  v_add_u32 v16, v5, v2
  v_add_u32 v2, 64, v1
  v_mul_u32_u24 v3, 171, v2
  v_lshrrev_b32 v3, 12, v3
  v_mul_u32_u24 v4, 24, v3
  v_sub_u32 v2, v2, v4
  v_lshrrev_b32 v4, 3, v2
  v_and_b32 v2, 7, v2
  v_bfe_u32 v5, v3, 1, 1
  v_lshlrev_b32 v5, 2, v5
  v_xor_b32 v2, v2, v5
  v_lshlrev_b32 v2, 4, v2
  v_mul_u32_u24 v5, 2752, v3
  v_lshl_add_u32 v5, v4, 7, v5
  v_add_u32 v17, v5, v2
  v_add_u32 v2, 128, v1
  v_mul_u32_u24 v3, 171, v2
  v_lshrrev_b32 v3, 12, v3
  v_mul_u32_u24 v4, 24, v3
  v_sub_u32 v2, v2, v4
  v_lshrrev_b32 v4, 3, v2
  v_and_b32 v2, 7, v2
  v_bfe_u32 v5, v3, 1, 1
  v_lshlrev_b32 v5, 2, v5
  v_xor_b32 v2, v2, v5
  v_lshlrev_b32 v2, 4, v2
  v_mul_u32_u24 v5, 2752, v3
  v_lshl_add_u32 v5, v4, 7, v5
  v_add_u32 v18, v5, v2
  s_lshl_b32 s71, s31, 6
  s_mul_i32 s72, s67, 22016
  s_add_u32 s71, s71, s72
  s_add_u32 m0, s68, 24576
  s_movk_i32 s81, 384
  s_waitcnt vmcnt(6)
  s_barrier
  buffer_load_dwordx4 v12, s[32:35], s81 offen lds
  s_add_u32 s82, s70, 589824
  s_add_u32 m0, s69, 73728
  s_nop 0
  buffer_load_dwordx4 v13, s[36:39], s82 offen lds
  s_add_u32 m0, s69, 74752
  s_nop 0
  buffer_load_dwordx4 v14, s[36:39], s82 offen lds
  s_add_u32 m0, s69, 75776
  s_nop 0
  buffer_load_dwordx4 v15, s[36:39], s82 offen lds
  s_add_u32 m0, s68, 32768
  s_movk_i32 s81, 512
  s_waitcnt vmcnt(7)
  s_barrier
  buffer_load_dwordx4 v12, s[32:35], s81 offen lds
  s_add_u32 s82, s70, 786432
  s_add_u32 m0, s69, 0
  s_nop 0
  buffer_load_dwordx4 v13, s[36:39], s82 offen lds
  s_add_u32 m0, s69, 1024
  s_nop 0
  buffer_load_dwordx4 v14, s[36:39], s82 offen lds
  s_add_u32 m0, s69, 2048
  s_nop 0
  buffer_load_dwordx4 v15, s[36:39], s82 offen lds
  s_add_u32 m0, s68, 40960
  s_movk_i32 s81, 640
  s_waitcnt vmcnt(8)
  s_barrier
  buffer_load_dwordx4 v12, s[32:35], s81 offen lds
  s_add_u32 s82, s70, 983040
  s_add_u32 m0, s69, 24576
  s_nop 0
  buffer_load_dwordx4 v13, s[36:39], s82 offen lds
  s_add_u32 m0, s69, 25600
  s_nop 0
  buffer_load_dwordx4 v14, s[36:39], s82 offen lds
  s_add_u32 m0, s69, 26624
  s_nop 0
  buffer_load_dwordx4 v15, s[36:39], s82 offen lds
  s_add_u32 m0, s68, 49152
  s_movk_i32 s81, 768
  s_waitcnt vmcnt(8)
  s_barrier
  buffer_load_dwordx4 v12, s[32:35], s81 offen lds
  s_add_u32 s82, s70, 1179648
  s_add_u32 m0, s69, 49152
  s_nop 0
  buffer_load_dwordx4 v13, s[36:39], s82 offen lds
  s_add_u32 m0, s69, 50176
  s_nop 0
  buffer_load_dwordx4 v14, s[36:39], s82 offen lds
  s_add_u32 m0, s69, 51200
  s_nop 0
  buffer_load_dwordx4 v15, s[36:39], s82 offen lds
  s_add_u32 m0, s68, 57344
  s_movk_i32 s81, 896
  s_waitcnt vmcnt(8)
  s_barrier
  buffer_load_dwordx4 v12, s[32:35], s81 offen lds
  s_add_u32 s82, s70, 1376256
  s_add_u32 m0, s69, 73728
  s_nop 0
  buffer_load_dwordx4 v13, s[36:39], s82 offen lds
  s_add_u32 m0, s69, 74752
  s_nop 0
  buffer_load_dwordx4 v14, s[36:39], s82 offen lds
  s_add_u32 m0, s69, 75776
  s_nop 0
  buffer_load_dwordx4 v15, s[36:39], s82 offen lds
  s_add_u32 s82, s71, 0
  s_add_u32 m0, s69, 0
  s_waitcnt vmcnt(8)
  s_barrier
  buffer_load_dwordx4 v16, s[40:43], s82 offen lds
  s_add_u32 m0, s69, 1024
  s_nop 0
  buffer_load_dwordx4 v17, s[40:43], s82 offen lds
  s_add_u32 m0, s69, 2048
  s_nop 0
  buffer_load_dwordx4 v18, s[40:43], s82 offen lds
  s_add_u32 s82, s71, 176128
  s_add_u32 m0, s69, 24576
  s_waitcnt vmcnt(7)
  s_barrier
  buffer_load_dwordx4 v16, s[40:43], s82 offen lds
  s_add_u32 m0, s69, 25600
  s_nop 0
  buffer_load_dwordx4 v17, s[40:43], s82 offen lds
  s_add_u32 m0, s69, 26624
  s_nop 0
  buffer_load_dwordx4 v18, s[40:43], s82 offen lds
  s_add_u32 s82, s71, 352256
  s_add_u32 m0, s69, 49152
  s_waitcnt vmcnt(6)
  s_barrier
  buffer_load_dwordx4 v16, s[40:43], s82 offen lds
  s_add_u32 m0, s69, 50176
  s_nop 0
  buffer_load_dwordx4 v17, s[40:43], s82 offen lds
  s_add_u32 m0, s69, 51200
  s_nop 0
  buffer_load_dwordx4 v18, s[40:43], s82 offen lds
  s_add_u32 s82, s71, 528384
  s_add_u32 m0, s69, 73728
  s_waitcnt vmcnt(6)
  s_barrier
  buffer_load_dwordx4 v16, s[40:43], s82 offen lds
  s_add_u32 m0, s69, 74752
  s_nop 0
  buffer_load_dwordx4 v17, s[40:43], s82 offen lds
  s_add_u32 m0, s69, 75776
  s_nop 0
  buffer_load_dwordx4 v18, s[40:43], s82 offen lds
  s_add_u32 s82, s71, 704512
  s_add_u32 m0, s69, 0
  s_waitcnt vmcnt(6)
  s_barrier
  buffer_load_dwordx4 v16, s[40:43], s82 offen lds
  s_add_u32 m0, s69, 1024
  s_nop 0
  buffer_load_dwordx4 v17, s[40:43], s82 offen lds
  s_add_u32 m0, s69, 2048
  s_nop 0
  buffer_load_dwordx4 v18, s[40:43], s82 offen lds
  s_add_u32 s82, s71, 880640
  s_add_u32 m0, s69, 24576
  s_waitcnt vmcnt(6)
  s_barrier
  buffer_load_dwordx4 v16, s[40:43], s82 offen lds
  s_add_u32 m0, s69, 25600
  s_nop 0
  buffer_load_dwordx4 v17, s[40:43], s82 offen lds
  s_add_u32 m0, s69, 26624
  s_nop 0
  buffer_load_dwordx4 v18, s[40:43], s82 offen lds
  s_add_u32 s82, s71, 1056768
  s_add_u32 m0, s69, 49152
  s_waitcnt vmcnt(6)
  s_barrier
  buffer_load_dwordx4 v16, s[40:43], s82 offen lds
  s_add_u32 m0, s69, 50176
  s_nop 0
  buffer_load_dwordx4 v17, s[40:43], s82 offen lds
  s_add_u32 m0, s69, 51200
  s_nop 0
  buffer_load_dwordx4 v18, s[40:43], s82 offen lds
  s_add_u32 s82, s71, 1232896
  s_add_u32 m0, s69, 73728
  s_waitcnt vmcnt(6)
  s_barrier
  buffer_load_dwordx4 v16, s[40:43], s82 offen lds
  s_add_u32 m0, s69, 74752
  s_nop 0
  buffer_load_dwordx4 v17, s[40:43], s82 offen lds
  s_add_u32 m0, s69, 75776
  s_nop 0
  buffer_load_dwordx4 v18, s[40:43], s82 offen lds
  s_waitcnt vmcnt(6)
  s_barrier
  s_waitcnt vmcnt(3)
  s_barrier
  s_waitcnt vmcnt(0)
  s_barrier
  s_barrier
  s_branch L_attn
L_cons:
  s_and_b32 s52, s2, 7
  s_lshr_b32 s53, s2, 3
  s_lshl_b32 s54, s53, 4
  s_lshl_b32 s55, s3, 2
  s_add_u32 s56, s54, s55
  v_lshlrev_b32 v20, 7, v1
  s_cmp_eq_u32 s3, 0
  s_cbranch_scc0 L_pfg1a
  s_mov_b32 s40, s4
  s_mov_b32 s41, s5
  s_mov_b32 s42, 2097152
  s_mov_b32 s43, 0x20000
  s_lshl_b32 s54, s2, 13
  buffer_load_dword v24, v20, s[40:43], s54 offen
  s_branch L_pfg1d
L_pfg1a:
  s_cmp_eq_u32 s3, 1
  s_cbranch_scc0 L_pfg1b
  s_mov_b32 s40, s6
  s_mov_b32 s41, s7
  s_mov_b32 s42, 1572864
  s_mov_b32 s43, 0x20000
  s_mul_i32 s54, s2, 6144
  s_mov_b32 exec_lo, 0xffffffff
  s_mov_b32 exec_hi, 0xffff
  buffer_load_dword v24, v20, s[40:43], s54 offen
  s_mov_b64 exec, -1
  s_branch L_pfg1d
L_pfg1b:
  s_cmp_eq_u32 s3, 2
  s_cbranch_scc0 L_pfg1c
  s_mov_b32 s40, s12
  s_mov_b32 s41, s13
  s_mov_b32 s42, 1409024
  s_mov_b32 s43, 0x20000
  s_mul_i32 s54, s2, 5504
  s_mov_b32 exec_lo, 0xffffffff
  s_mov_b32 exec_hi, 0x7ff
  buffer_load_dword v24, v20, s[40:43], s54 offen
  s_mov_b64 exec, -1
  s_branch L_pfg1d
L_pfg1c:
L_pfg1d:
  v_lshrrev_b32 v2, 5, v1
  s_and_b32 s63, s3, 1
  s_lshr_b32 s64, s3, 1
  s_mov_b32 s44, s14
  s_mov_b32 s45, s15
  s_mov_b32 s46, 2752
  s_mov_b32 s47, 0x20000
  s_add_u32 s54, s31, s63
  s_lshl_b32 s54, s54, 6
  v_lshlrev_b32 v3, 3, v2
  buffer_load_dwordx2 v[80:81], v3, s[44:47], s54 offen offset:0
  buffer_load_dwordx2 v[82:83], v3, s[44:47], s54 offen offset:16
  buffer_load_dwordx2 v[84:85], v3, s[44:47], s54 offen offset:32
  buffer_load_dwordx2 v[86:87], v3, s[44:47], s54 offen offset:48
  buffer_load_dwordx2 v[88:89], v3, s[44:47], s54 offen offset:128
  buffer_load_dwordx2 v[90:91], v3, s[44:47], s54 offen offset:144
  buffer_load_dwordx2 v[92:93], v3, s[44:47], s54 offen offset:160
  buffer_load_dwordx2 v[94:95], v3, s[44:47], s54 offen offset:176
  buffer_load_dwordx2 v[96:97], v3, s[44:47], s54 offen offset:256
  buffer_load_dwordx2 v[98:99], v3, s[44:47], s54 offen offset:272
  buffer_load_dwordx2 v[100:101], v3, s[44:47], s54 offen offset:288
  buffer_load_dwordx2 v[102:103], v3, s[44:47], s54 offen offset:304
  v_mov_b32 v32, 0
  v_mov_b32 v33, 0
  v_mov_b32 v34, 0
  v_mov_b32 v35, 0
  v_mov_b32 v36, 0
  v_mov_b32 v37, 0
  v_mov_b32 v38, 0
  v_mov_b32 v39, 0
  v_mov_b32 v40, 0
  v_mov_b32 v41, 0
  v_mov_b32 v42, 0
  v_mov_b32 v43, 0
  v_mov_b32 v44, 0
  v_mov_b32 v45, 0
  v_mov_b32 v46, 0
  v_mov_b32 v47, 0
  v_mov_b32 v48, 0
  v_mov_b32 v49, 0
  v_mov_b32 v50, 0
  v_mov_b32 v51, 0
  v_mov_b32 v52, 0
  v_mov_b32 v53, 0
  v_mov_b32 v54, 0
  v_mov_b32 v55, 0
  v_mov_b32 v56, 0
  v_mov_b32 v57, 0
  v_mov_b32 v58, 0
  v_mov_b32 v59, 0
  v_mov_b32 v60, 0
  v_mov_b32 v61, 0
  v_mov_b32 v62, 0
  v_mov_b32 v63, 0
  v_mov_b32 v64, 0
  v_mov_b32 v65, 0
  v_mov_b32 v66, 0
  v_mov_b32 v67, 0
  v_mov_b32 v68, 0
  v_mov_b32 v69, 0
  v_mov_b32 v70, 0
  v_mov_b32 v71, 0
  v_mov_b32 v72, 0
  v_mov_b32 v73, 0
  v_mov_b32 v74, 0
  v_mov_b32 v75, 0
  v_mov_b32 v76, 0
  v_mov_b32 v77, 0
  v_mov_b32 v78, 0
  v_mov_b32 v79, 0
  v_and_b32 v16, 31, v1
  v_bfe_u32 v17, v1, 1, 3
  s_lshl_b32 s54, s64, 5
  v_add_u32 v16, s54, v16
  v_lshlrev_b32 v16, 7, v16
  v_xor_b32 v17, v17, v2
  v_xor_b32 v18, 0, v17
  v_lshl_add_u32 v8, v18, 4, v16
  v_xor_b32 v18, 2, v17
  v_lshl_add_u32 v9, v18, 4, v16
  v_xor_b32 v18, 4, v17
  v_lshl_add_u32 v10, v18, 4, v16
  v_xor_b32 v18, 6, v17
  v_lshl_add_u32 v11, v18, 4, v16
  v_bfe_u32 v16, v1, 2, 2
  v_lshrrev_b32 v17, 5, v1
  v_mul_u32_u24 v17, 8, v17
  v_add_u32 v16, v16, v17
  v_mul_u32_u24 v12, 384, v16
  v_bfe_u32 v16, v1, 4, 1
  v_lshlrev_b32 v16, 1, v16
  v_bfe_u32 v17, v1, 1, 1
  v_add_u32 v16, v16, v17
  v_bfe_u32 v17, v1, 3, 1
  v_lshlrev_b32 v17, 2, v17
  v_xor_b32 v16, v16, v17
  v_lshl_add_u32 v12, v16, 4, v12
  v_and_b32 v16, 1, v1
  v_lshl_add_u32 v12, v16, 3, v12
  s_lshl_b32 s54, s63, 6
  v_xor_b32 v12, s54, v12
  v_add_u32 v12, 0x10000, v12
  v_add_u32 v13, 49152, v12
  s_barrier
  ds_read_b128 v[104:107], v8 offset:0
  ds_read_b64_tr_b16 v[112:113], v12 offset:0
  ds_read_b64_tr_b16 v[114:115], v12 offset:1536
  ds_read_b64_tr_b16 v[116:117], v12 offset:128
  ds_read_b64_tr_b16 v[118:119], v12 offset:1664
  ds_read_b64_tr_b16 v[120:121], v12 offset:256
  ds_read_b64_tr_b16 v[122:123], v12 offset:1792
  ds_read_b128 v[108:111], v9 offset:0
  ds_read_b64_tr_b16 v[124:125], v12 offset:6144
  ds_read_b64_tr_b16 v[126:127], v12 offset:7680
  ds_read_b64_tr_b16 v[128:129], v12 offset:6272
  ds_read_b64_tr_b16 v[130:131], v12 offset:7808
  ds_read_b64_tr_b16 v[132:133], v12 offset:6400
  ds_read_b64_tr_b16 v[134:135], v12 offset:7936
  s_mov_b32 s65, 0x8000
L_loop_q:
  s_waitcnt lgkmcnt(0)
  v_mfma_f32_32x32x16_bf16 v[32:47], v[112:115], v[104:107], v[32:47]
  ds_read_b128 v[136:139], v10 offset:0
  ds_read_b64_tr_b16 v[144:145], v12 offset:12288
  ds_read_b64_tr_b16 v[146:147], v12 offset:13824
  ds_read_b64_tr_b16 v[148:149], v12 offset:12416
  v_mfma_f32_32x32x16_bf16 v[48:63], v[116:119], v[104:107], v[48:63]
  ds_read_b64_tr_b16 v[150:151], v12 offset:13952
  ds_read_b64_tr_b16 v[152:153], v12 offset:12544
  ds_read_b64_tr_b16 v[154:155], v12 offset:14080
  ds_read_b128 v[140:143], v11 offset:0
  v_mfma_f32_32x32x16_bf16 v[64:79], v[104:107], v[120:123], v[64:79]
  ds_read_b64_tr_b16 v[156:157], v12 offset:18432
  ds_read_b64_tr_b16 v[158:159], v12 offset:19968
  ds_read_b64_tr_b16 v[160:161], v12 offset:18560
  v_mfma_f32_32x32x16_bf16 v[32:47], v[124:127], v[108:111], v[32:47]
  ds_read_b64_tr_b16 v[162:163], v12 offset:20096
  ds_read_b64_tr_b16 v[164:165], v12 offset:18688
  ds_read_b64_tr_b16 v[166:167], v12 offset:20224
  v_mfma_f32_32x32x16_bf16 v[48:63], v[128:131], v[108:111], v[48:63]
  v_mfma_f32_32x32x16_bf16 v[64:79], v[108:111], v[132:135], v[64:79]
  s_waitcnt lgkmcnt(0)
  s_barrier
  v_mfma_f32_32x32x16_bf16 v[32:47], v[144:147], v[136:139], v[32:47]
  ds_read_b128 v[104:107], v8 offset:8192
  ds_read_b64_tr_b16 v[112:113], v12 offset:24576
  ds_read_b64_tr_b16 v[114:115], v12 offset:26112
  ds_read_b64_tr_b16 v[116:117], v12 offset:24704
  v_mfma_f32_32x32x16_bf16 v[48:63], v[148:151], v[136:139], v[48:63]
  ds_read_b64_tr_b16 v[118:119], v12 offset:26240
  ds_read_b64_tr_b16 v[120:121], v12 offset:24832
  ds_read_b64_tr_b16 v[122:123], v12 offset:26368
  ds_read_b128 v[108:111], v9 offset:8192
  v_mfma_f32_32x32x16_bf16 v[64:79], v[136:139], v[152:155], v[64:79]
  ds_read_b64_tr_b16 v[124:125], v12 offset:30720
  ds_read_b64_tr_b16 v[126:127], v12 offset:32256
  ds_read_b64_tr_b16 v[128:129], v12 offset:30848
  v_mfma_f32_32x32x16_bf16 v[32:47], v[156:159], v[140:143], v[32:47]
  ds_read_b64_tr_b16 v[130:131], v12 offset:32384
  ds_read_b64_tr_b16 v[132:133], v12 offset:30976
  ds_read_b64_tr_b16 v[134:135], v12 offset:32512
  v_mfma_f32_32x32x16_bf16 v[48:63], v[160:163], v[140:143], v[48:63]
  v_mfma_f32_32x32x16_bf16 v[64:79], v[140:143], v[164:167], v[64:79]
  s_waitcnt lgkmcnt(0)
  v_mfma_f32_32x32x16_bf16 v[32:47], v[112:115], v[104:107], v[32:47]
  ds_read_b128 v[136:139], v10 offset:8192
  ds_read_b64_tr_b16 v[144:145], v12 offset:36864
  ds_read_b64_tr_b16 v[146:147], v12 offset:38400
  ds_read_b64_tr_b16 v[148:149], v12 offset:36992
  v_mfma_f32_32x32x16_bf16 v[48:63], v[116:119], v[104:107], v[48:63]
  ds_read_b64_tr_b16 v[150:151], v12 offset:38528
  ds_read_b64_tr_b16 v[152:153], v12 offset:37120
  ds_read_b64_tr_b16 v[154:155], v12 offset:38656
  ds_read_b128 v[140:143], v11 offset:8192
  v_mfma_f32_32x32x16_bf16 v[64:79], v[104:107], v[120:123], v[64:79]
  ds_read_b64_tr_b16 v[156:157], v12 offset:43008
  ds_read_b64_tr_b16 v[158:159], v12 offset:44544
  ds_read_b64_tr_b16 v[160:161], v12 offset:43136
  v_mfma_f32_32x32x16_bf16 v[32:47], v[124:127], v[108:111], v[32:47]
  ds_read_b64_tr_b16 v[162:163], v12 offset:44672
  ds_read_b64_tr_b16 v[164:165], v12 offset:43264
  ds_read_b64_tr_b16 v[166:167], v12 offset:44800
  v_mfma_f32_32x32x16_bf16 v[48:63], v[128:131], v[108:111], v[48:63]
  v_mfma_f32_32x32x16_bf16 v[64:79], v[108:111], v[132:135], v[64:79]
  s_waitcnt lgkmcnt(0)
  s_barrier
  v_mfma_f32_32x32x16_bf16 v[32:47], v[144:147], v[136:139], v[32:47]
  ds_read_b128 v[104:107], v8 offset:16384
  ds_read_b64_tr_b16 v[112:113], v13 offset:0
  ds_read_b64_tr_b16 v[114:115], v13 offset:1536
  ds_read_b64_tr_b16 v[116:117], v13 offset:128
  v_mfma_f32_32x32x16_bf16 v[48:63], v[148:151], v[136:139], v[48:63]
  ds_read_b64_tr_b16 v[118:119], v13 offset:1664
  ds_read_b64_tr_b16 v[120:121], v13 offset:256
  ds_read_b64_tr_b16 v[122:123], v13 offset:1792
  ds_read_b128 v[108:111], v9 offset:16384
  v_mfma_f32_32x32x16_bf16 v[64:79], v[136:139], v[152:155], v[64:79]
  ds_read_b64_tr_b16 v[124:125], v13 offset:6144
  ds_read_b64_tr_b16 v[126:127], v13 offset:7680
  ds_read_b64_tr_b16 v[128:129], v13 offset:6272
  v_mfma_f32_32x32x16_bf16 v[32:47], v[156:159], v[140:143], v[32:47]
  ds_read_b64_tr_b16 v[130:131], v13 offset:7808
  ds_read_b64_tr_b16 v[132:133], v13 offset:6400
  ds_read_b64_tr_b16 v[134:135], v13 offset:7936
  v_mfma_f32_32x32x16_bf16 v[48:63], v[160:163], v[140:143], v[48:63]
  v_mfma_f32_32x32x16_bf16 v[64:79], v[140:143], v[164:167], v[64:79]
  s_waitcnt lgkmcnt(0)
  v_mfma_f32_32x32x16_bf16 v[32:47], v[112:115], v[104:107], v[32:47]
  ds_read_b128 v[136:139], v10 offset:16384
  ds_read_b64_tr_b16 v[144:145], v13 offset:12288
  ds_read_b64_tr_b16 v[146:147], v13 offset:13824
  ds_read_b64_tr_b16 v[148:149], v13 offset:12416
  v_mfma_f32_32x32x16_bf16 v[48:63], v[116:119], v[104:107], v[48:63]
  ds_read_b64_tr_b16 v[150:151], v13 offset:13952
  ds_read_b64_tr_b16 v[152:153], v13 offset:12544
  ds_read_b64_tr_b16 v[154:155], v13 offset:14080
  ds_read_b128 v[140:143], v11 offset:16384
  v_mfma_f32_32x32x16_bf16 v[64:79], v[104:107], v[120:123], v[64:79]
  ds_read_b64_tr_b16 v[156:157], v13 offset:18432
  ds_read_b64_tr_b16 v[158:159], v13 offset:19968
  ds_read_b64_tr_b16 v[160:161], v13 offset:18560
  v_mfma_f32_32x32x16_bf16 v[32:47], v[124:127], v[108:111], v[32:47]
  ds_read_b64_tr_b16 v[162:163], v13 offset:20096
  ds_read_b64_tr_b16 v[164:165], v13 offset:18688
  ds_read_b64_tr_b16 v[166:167], v13 offset:20224
  v_mfma_f32_32x32x16_bf16 v[48:63], v[128:131], v[108:111], v[48:63]
  v_mfma_f32_32x32x16_bf16 v[64:79], v[108:111], v[132:135], v[64:79]
  s_waitcnt lgkmcnt(0)
  s_barrier
  v_mfma_f32_32x32x16_bf16 v[32:47], v[144:147], v[136:139], v[32:47]
  ds_read_b128 v[104:107], v8 offset:24576
  ds_read_b64_tr_b16 v[112:113], v13 offset:24576
  ds_read_b64_tr_b16 v[114:115], v13 offset:26112
  ds_read_b64_tr_b16 v[116:117], v13 offset:24704
  v_mfma_f32_32x32x16_bf16 v[48:63], v[148:151], v[136:139], v[48:63]
  ds_read_b64_tr_b16 v[118:119], v13 offset:26240
  ds_read_b64_tr_b16 v[120:121], v13 offset:24832
  ds_read_b64_tr_b16 v[122:123], v13 offset:26368
  ds_read_b128 v[108:111], v9 offset:24576
  v_mfma_f32_32x32x16_bf16 v[64:79], v[136:139], v[152:155], v[64:79]
  ds_read_b64_tr_b16 v[124:125], v13 offset:30720
  ds_read_b64_tr_b16 v[126:127], v13 offset:32256
  ds_read_b64_tr_b16 v[128:129], v13 offset:30848
  v_mfma_f32_32x32x16_bf16 v[32:47], v[156:159], v[140:143], v[32:47]
  ds_read_b64_tr_b16 v[130:131], v13 offset:32384
  ds_read_b64_tr_b16 v[132:133], v13 offset:30976
  ds_read_b64_tr_b16 v[134:135], v13 offset:32512
  v_mfma_f32_32x32x16_bf16 v[48:63], v[160:163], v[140:143], v[48:63]
  v_mfma_f32_32x32x16_bf16 v[64:79], v[140:143], v[164:167], v[64:79]
  s_waitcnt lgkmcnt(0)
  v_mfma_f32_32x32x16_bf16 v[32:47], v[112:115], v[104:107], v[32:47]
  ds_read_b128 v[136:139], v10 offset:24576
  ds_read_b64_tr_b16 v[144:145], v13 offset:36864
  ds_read_b64_tr_b16 v[146:147], v13 offset:38400
  ds_read_b64_tr_b16 v[148:149], v13 offset:36992
  v_mfma_f32_32x32x16_bf16 v[48:63], v[116:119], v[104:107], v[48:63]
  ds_read_b64_tr_b16 v[150:151], v13 offset:38528
  ds_read_b64_tr_b16 v[152:153], v13 offset:37120
  ds_read_b64_tr_b16 v[154:155], v13 offset:38656
  ds_read_b128 v[140:143], v11 offset:24576
  v_mfma_f32_32x32x16_bf16 v[64:79], v[104:107], v[120:123], v[64:79]
  ds_read_b64_tr_b16 v[156:157], v13 offset:43008
  ds_read_b64_tr_b16 v[158:159], v13 offset:44544
  ds_read_b64_tr_b16 v[160:161], v13 offset:43136
  v_mfma_f32_32x32x16_bf16 v[32:47], v[124:127], v[108:111], v[32:47]
  ds_read_b64_tr_b16 v[162:163], v13 offset:44672
  ds_read_b64_tr_b16 v[164:165], v13 offset:43264
  ds_read_b64_tr_b16 v[166:167], v13 offset:44800
  v_mfma_f32_32x32x16_bf16 v[48:63], v[128:131], v[108:111], v[48:63]
  v_mfma_f32_32x32x16_bf16 v[64:79], v[108:111], v[132:135], v[64:79]
  s_waitcnt lgkmcnt(0)
  v_add_u32 v8, s65, v8
  v_add_u32 v9, s65, v9
  v_add_u32 v10, s65, v10
  v_add_u32 v11, s65, v11
  s_barrier
  s_cmp_lt_i32 s65, 0
  s_cbranch_scc1 L_qtail
  v_mfma_f32_32x32x16_bf16 v[32:47], v[144:147], v[136:139], v[32:47]
  ds_read_b128 v[104:107], v8 offset:0
  ds_read_b64_tr_b16 v[112:113], v12 offset:0
  ds_read_b64_tr_b16 v[114:115], v12 offset:1536
  ds_read_b64_tr_b16 v[116:117], v12 offset:128
  v_mfma_f32_32x32x16_bf16 v[48:63], v[148:151], v[136:139], v[48:63]
  ds_read_b64_tr_b16 v[118:119], v12 offset:1664
  ds_read_b64_tr_b16 v[120:121], v12 offset:256
  ds_read_b64_tr_b16 v[122:123], v12 offset:1792
  ds_read_b128 v[108:111], v9 offset:0
  v_mfma_f32_32x32x16_bf16 v[64:79], v[136:139], v[152:155], v[64:79]
  ds_read_b64_tr_b16 v[124:125], v12 offset:6144
  ds_read_b64_tr_b16 v[126:127], v12 offset:7680
  ds_read_b64_tr_b16 v[128:129], v12 offset:6272
  v_mfma_f32_32x32x16_bf16 v[32:47], v[156:159], v[140:143], v[32:47]
  ds_read_b64_tr_b16 v[130:131], v12 offset:7808
  ds_read_b64_tr_b16 v[132:133], v12 offset:6400
  ds_read_b64_tr_b16 v[134:135], v12 offset:7936
  v_mfma_f32_32x32x16_bf16 v[48:63], v[160:163], v[140:143], v[48:63]
  v_mfma_f32_32x32x16_bf16 v[64:79], v[140:143], v[164:167], v[64:79]
  s_mov_b32 s65, 0xffff8000
  s_branch L_loop_q
L_qtail:
  v_mfma_f32_32x32x16_bf16 v[32:47], v[144:147], v[136:139], v[32:47]
  ds_read_b128 v[104:107], v8 offset:0
  ds_read_b64_tr_b16 v[112:113], v12 offset:0
  ds_read_b64_tr_b16 v[114:115], v12 offset:1536
  ds_read_b64_tr_b16 v[116:117], v12 offset:128
  v_mfma_f32_32x32x16_bf16 v[48:63], v[148:151], v[136:139], v[48:63]
  ds_read_b64_tr_b16 v[118:119], v12 offset:1664
  ds_read_b64_tr_b16 v[120:121], v12 offset:256
  ds_read_b64_tr_b16 v[122:123], v12 offset:1792
  ds_read_b128 v[108:111], v9 offset:0
  v_mfma_f32_32x32x16_bf16 v[64:79], v[136:139], v[152:155], v[64:79]
  ds_read_b64_tr_b16 v[124:125], v12 offset:6144
  ds_read_b64_tr_b16 v[126:127], v12 offset:7680
  ds_read_b64_tr_b16 v[128:129], v12 offset:6272
  v_mfma_f32_32x32x16_bf16 v[32:47], v[156:159], v[140:143], v[32:47]
  ds_read_b64_tr_b16 v[130:131], v12 offset:7808
  ds_read_b64_tr_b16 v[132:133], v12 offset:6400
  ds_read_b64_tr_b16 v[134:135], v12 offset:7936
  v_mfma_f32_32x32x16_bf16 v[48:63], v[160:163], v[140:143], v[48:63]
  v_mfma_f32_32x32x16_bf16 v[64:79], v[140:143], v[164:167], v[64:79]
  s_mov_b32 s32, s26
  s_mov_b32 s33, s27
  s_mov_b32 s34, 6303744
  s_mov_b32 s35, 0x20000
  s_lshl_b32 s54, s29, 1
  s_add_u32 s54, s54, s64
  s_lshl_b32 s55, s30, 2
  s_lshl_b32 s56, s63, 1
  s_add_u32 s55, s55, s56
  s_lshl_b32 s55, s55, 6
  s_add_u32 s54, s54, s55
  s_lshl_b32 s54, s54, 10
  v_lshlrev_b32 v3, 4, v1
  v_bfe_u32 v4, v1, 4, 1
  v_lshlrev_b32 v4, 16, v4
  v_lshl_add_u32 v4, v2, 8, v4
  v_and_b32 v5, 15, v1
  v_lshl_add_u32 v4, v5, 4, v4
  s_mov_b32 s56, 0x3eb8aa3b
  s_waitcnt vmcnt(0)
  s_nop 4
  v_cvt_pk_bf16_f32 v48, v48, v49
  v_cvt_pk_bf16_f32 v49, v50, v51
  v_cvt_pk_bf16_f32 v50, v52, v53
  v_cvt_pk_bf16_f32 v51, v54, v55
  v_cvt_pk_bf16_f32 v52, v56, v57
  v_cvt_pk_bf16_f32 v53, v58, v59
  v_cvt_pk_bf16_f32 v54, v60, v61
  v_cvt_pk_bf16_f32 v55, v62, v63
  s_add_u32 s55, s54, 2105344
  buffer_store_dwordx4 v[48:51], v3, s[32:35], s55 offen sc1
  s_add_u32 s55, s54, 2170880
  buffer_store_dwordx4 v[52:55], v3, s[32:35], s55 offen sc1
  v_cvt_pk_bf16_f32 v64, v64, v65
  v_cvt_pk_bf16_f32 v65, v66, v67
  v_cvt_pk_bf16_f32 v66, v68, v69
  v_cvt_pk_bf16_f32 v67, v70, v71
  v_cvt_pk_bf16_f32 v68, v72, v73
  v_cvt_pk_bf16_f32 v69, v74, v75
  v_cvt_pk_bf16_f32 v70, v76, v77
  v_cvt_pk_bf16_f32 v71, v78, v79
  s_add_u32 s55, s54, 4206592
  buffer_store_dwordx4 v[64:67], v4, s[32:35], s55 offen offset:0 sc1
  buffer_store_dwordx4 v[68:71], v4, s[32:35], s55 offen offset:512 sc1
  v_mul_f32 v32, s56, v32
  v_mul_f32 v33, s56, v33
  v_mul_f32 v34, s56, v34
  v_mul_f32 v35, s56, v35
  v_mul_f32 v36, s56, v36
  v_mul_f32 v37, s56, v37
  v_mul_f32 v38, s56, v38
  v_mul_f32 v39, s56, v39
  v_mul_f32 v40, s56, v40
  v_mul_f32 v41, s56, v41
  v_mul_f32 v42, s56, v42
  v_mul_f32 v43, s56, v43
  v_mul_f32 v44, s56, v44
  v_mul_f32 v45, s56, v45
  v_mul_f32 v46, s56, v46
  v_mul_f32 v47, s56, v47
  v_cvt_pk_bf16_f32 v32, v32, v33
  v_cvt_pk_bf16_f32 v33, v34, v35
  v_cvt_pk_bf16_f32 v34, v36, v37
  v_cvt_pk_bf16_f32 v35, v38, v39
  v_cvt_pk_bf16_f32 v36, v40, v41
  v_cvt_pk_bf16_f32 v37, v42, v43
  v_cvt_pk_bf16_f32 v38, v44, v45
  v_cvt_pk_bf16_f32 v39, v46, v47
  s_add_u32 s55, s54, 4096
  buffer_store_dwordx4 v[32:35], v3, s[32:35], s55 offen sc1
  s_add_u32 s55, s54, 69632
  buffer_store_dwordx4 v[36:39], v3, s[32:35], s55 offen sc1
  s_nop 1
  v_lshlrev_b32 v32, 16, v80
  v_and_b32 v33, 0xffff0000, v80
  v_lshlrev_b32 v34, 16, v81
  v_and_b32 v35, 0xffff0000, v81
  v_lshlrev_b32 v36, 16, v82
  v_and_b32 v37, 0xffff0000, v82
  v_lshlrev_b32 v38, 16, v83
  v_and_b32 v39, 0xffff0000, v83
  v_lshlrev_b32 v40, 16, v84
  v_and_b32 v41, 0xffff0000, v84
  v_lshlrev_b32 v42, 16, v85
  v_and_b32 v43, 0xffff0000, v85
  v_lshlrev_b32 v44, 16, v86
  v_and_b32 v45, 0xffff0000, v86
  v_lshlrev_b32 v46, 16, v87
  v_and_b32 v47, 0xffff0000, v87
  v_lshlrev_b32 v48, 16, v88
  v_and_b32 v49, 0xffff0000, v88
  v_lshlrev_b32 v50, 16, v89
  v_and_b32 v51, 0xffff0000, v89
  v_lshlrev_b32 v52, 16, v90
  v_and_b32 v53, 0xffff0000, v90
  v_lshlrev_b32 v54, 16, v91
  v_and_b32 v55, 0xffff0000, v91
  v_lshlrev_b32 v56, 16, v92
  v_and_b32 v57, 0xffff0000, v92
  v_lshlrev_b32 v58, 16, v93
  v_and_b32 v59, 0xffff0000, v93
  v_lshlrev_b32 v60, 16, v94
  v_and_b32 v61, 0xffff0000, v94
  v_lshlrev_b32 v62, 16, v95
  v_and_b32 v63, 0xffff0000, v95
  v_lshlrev_b32 v64, 16, v96
  v_and_b32 v65, 0xffff0000, v96
  v_lshlrev_b32 v66, 16, v97
  v_and_b32 v67, 0xffff0000, v97
  v_lshlrev_b32 v68, 16, v98
  v_and_b32 v69, 0xffff0000, v98
  v_lshlrev_b32 v70, 16, v99
  v_and_b32 v71, 0xffff0000, v99
  v_lshlrev_b32 v72, 16, v100
  v_and_b32 v73, 0xffff0000, v100
  v_lshlrev_b32 v74, 16, v101
  v_and_b32 v75, 0xffff0000, v101
  v_lshlrev_b32 v76, 16, v102
  v_and_b32 v77, 0xffff0000, v102
  v_lshlrev_b32 v78, 16, v103
  v_and_b32 v79, 0xffff0000, v103
  s_mov_b32 s65, 0x8000
L_loop_f:
  s_waitcnt lgkmcnt(0)
  v_mfma_f32_32x32x16_bf16 v[32:47], v[112:115], v[104:107], v[32:47]
  ds_read_b128 v[136:139], v10 offset:0
  ds_read_b64_tr_b16 v[144:145], v12 offset:12288
  ds_read_b64_tr_b16 v[146:147], v12 offset:13824
  ds_read_b64_tr_b16 v[148:149], v12 offset:12416
  v_mfma_f32_32x32x16_bf16 v[48:63], v[116:119], v[104:107], v[48:63]
  ds_read_b64_tr_b16 v[150:151], v12 offset:13952
  ds_read_b64_tr_b16 v[152:153], v12 offset:12544
  ds_read_b64_tr_b16 v[154:155], v12 offset:14080
  ds_read_b128 v[140:143], v11 offset:0
  v_mfma_f32_32x32x16_bf16 v[64:79], v[120:123], v[104:107], v[64:79]
  ds_read_b64_tr_b16 v[156:157], v12 offset:18432
  ds_read_b64_tr_b16 v[158:159], v12 offset:19968
  ds_read_b64_tr_b16 v[160:161], v12 offset:18560
  v_mfma_f32_32x32x16_bf16 v[32:47], v[124:127], v[108:111], v[32:47]
  ds_read_b64_tr_b16 v[162:163], v12 offset:20096
  ds_read_b64_tr_b16 v[164:165], v12 offset:18688
  ds_read_b64_tr_b16 v[166:167], v12 offset:20224
  v_mfma_f32_32x32x16_bf16 v[48:63], v[128:131], v[108:111], v[48:63]
  v_mfma_f32_32x32x16_bf16 v[64:79], v[132:135], v[108:111], v[64:79]
  s_waitcnt lgkmcnt(0)
  s_barrier
  v_mfma_f32_32x32x16_bf16 v[32:47], v[144:147], v[136:139], v[32:47]
  ds_read_b128 v[104:107], v8 offset:8192
  ds_read_b64_tr_b16 v[112:113], v12 offset:24576
  ds_read_b64_tr_b16 v[114:115], v12 offset:26112
  ds_read_b64_tr_b16 v[116:117], v12 offset:24704
  v_mfma_f32_32x32x16_bf16 v[48:63], v[148:151], v[136:139], v[48:63]
  ds_read_b64_tr_b16 v[118:119], v12 offset:26240
  ds_read_b64_tr_b16 v[120:121], v12 offset:24832
  ds_read_b64_tr_b16 v[122:123], v12 offset:26368
  ds_read_b128 v[108:111], v9 offset:8192
  v_mfma_f32_32x32x16_bf16 v[64:79], v[152:155], v[136:139], v[64:79]
  ds_read_b64_tr_b16 v[124:125], v12 offset:30720
  ds_read_b64_tr_b16 v[126:127], v12 offset:32256
  ds_read_b64_tr_b16 v[128:129], v12 offset:30848
  v_mfma_f32_32x32x16_bf16 v[32:47], v[156:159], v[140:143], v[32:47]
  ds_read_b64_tr_b16 v[130:131], v12 offset:32384
  ds_read_b64_tr_b16 v[132:133], v12 offset:30976
  ds_read_b64_tr_b16 v[134:135], v12 offset:32512
  v_mfma_f32_32x32x16_bf16 v[48:63], v[160:163], v[140:143], v[48:63]
  v_mfma_f32_32x32x16_bf16 v[64:79], v[164:167], v[140:143], v[64:79]
  s_waitcnt lgkmcnt(0)
  v_mfma_f32_32x32x16_bf16 v[32:47], v[112:115], v[104:107], v[32:47]
  ds_read_b128 v[136:139], v10 offset:8192
  ds_read_b64_tr_b16 v[144:145], v12 offset:36864
  ds_read_b64_tr_b16 v[146:147], v12 offset:38400
  ds_read_b64_tr_b16 v[148:149], v12 offset:36992
  v_mfma_f32_32x32x16_bf16 v[48:63], v[116:119], v[104:107], v[48:63]
  ds_read_b64_tr_b16 v[150:151], v12 offset:38528
  ds_read_b64_tr_b16 v[152:153], v12 offset:37120
  ds_read_b64_tr_b16 v[154:155], v12 offset:38656
  ds_read_b128 v[140:143], v11 offset:8192
  v_mfma_f32_32x32x16_bf16 v[64:79], v[120:123], v[104:107], v[64:79]
  ds_read_b64_tr_b16 v[156:157], v12 offset:43008
  ds_read_b64_tr_b16 v[158:159], v12 offset:44544
  ds_read_b64_tr_b16 v[160:161], v12 offset:43136
  v_mfma_f32_32x32x16_bf16 v[32:47], v[124:127], v[108:111], v[32:47]
  ds_read_b64_tr_b16 v[162:163], v12 offset:44672
  ds_read_b64_tr_b16 v[164:165], v12 offset:43264
  ds_read_b64_tr_b16 v[166:167], v12 offset:44800
  v_mfma_f32_32x32x16_bf16 v[48:63], v[128:131], v[108:111], v[48:63]
  v_mfma_f32_32x32x16_bf16 v[64:79], v[132:135], v[108:111], v[64:79]
  s_waitcnt lgkmcnt(0)
  s_barrier
  v_mfma_f32_32x32x16_bf16 v[32:47], v[144:147], v[136:139], v[32:47]
  ds_read_b128 v[104:107], v8 offset:16384
  ds_read_b64_tr_b16 v[112:113], v13 offset:0
  ds_read_b64_tr_b16 v[114:115], v13 offset:1536
  ds_read_b64_tr_b16 v[116:117], v13 offset:128
  v_mfma_f32_32x32x16_bf16 v[48:63], v[148:151], v[136:139], v[48:63]
  ds_read_b64_tr_b16 v[118:119], v13 offset:1664
  ds_read_b64_tr_b16 v[120:121], v13 offset:256
  ds_read_b64_tr_b16 v[122:123], v13 offset:1792
  ds_read_b128 v[108:111], v9 offset:16384
  v_mfma_f32_32x32x16_bf16 v[64:79], v[152:155], v[136:139], v[64:79]
  ds_read_b64_tr_b16 v[124:125], v13 offset:6144
  ds_read_b64_tr_b16 v[126:127], v13 offset:7680
  ds_read_b64_tr_b16 v[128:129], v13 offset:6272
  v_mfma_f32_32x32x16_bf16 v[32:47], v[156:159], v[140:143], v[32:47]
  ds_read_b64_tr_b16 v[130:131], v13 offset:7808
  ds_read_b64_tr_b16 v[132:133], v13 offset:6400
  ds_read_b64_tr_b16 v[134:135], v13 offset:7936
  v_mfma_f32_32x32x16_bf16 v[48:63], v[160:163], v[140:143], v[48:63]
  v_mfma_f32_32x32x16_bf16 v[64:79], v[164:167], v[140:143], v[64:79]
  s_waitcnt lgkmcnt(0)
  v_mfma_f32_32x32x16_bf16 v[32:47], v[112:115], v[104:107], v[32:47]
  ds_read_b128 v[136:139], v10 offset:16384
  ds_read_b64_tr_b16 v[144:145], v13 offset:12288
  ds_read_b64_tr_b16 v[146:147], v13 offset:13824
  ds_read_b64_tr_b16 v[148:149], v13 offset:12416
  v_mfma_f32_32x32x16_bf16 v[48:63], v[116:119], v[104:107], v[48:63]
  ds_read_b64_tr_b16 v[150:151], v13 offset:13952
  ds_read_b64_tr_b16 v[152:153], v13 offset:12544
  ds_read_b64_tr_b16 v[154:155], v13 offset:14080
  ds_read_b128 v[140:143], v11 offset:16384
  v_mfma_f32_32x32x16_bf16 v[64:79], v[120:123], v[104:107], v[64:79]
  ds_read_b64_tr_b16 v[156:157], v13 offset:18432
  ds_read_b64_tr_b16 v[158:159], v13 offset:19968
  ds_read_b64_tr_b16 v[160:161], v13 offset:18560
  v_mfma_f32_32x32x16_bf16 v[32:47], v[124:127], v[108:111], v[32:47]
  ds_read_b64_tr_b16 v[162:163], v13 offset:20096
  ds_read_b64_tr_b16 v[164:165], v13 offset:18688
  ds_read_b64_tr_b16 v[166:167], v13 offset:20224
  v_mfma_f32_32x32x16_bf16 v[48:63], v[128:131], v[108:111], v[48:63]
  v_mfma_f32_32x32x16_bf16 v[64:79], v[132:135], v[108:111], v[64:79]
  s_waitcnt vmcnt(0)
  s_waitcnt lgkmcnt(0)
  s_barrier
  v_mfma_f32_32x32x16_bf16 v[32:47], v[144:147], v[136:139], v[32:47]
  ds_read_b128 v[104:107], v8 offset:24576
  ds_read_b64_tr_b16 v[112:113], v13 offset:24576
  ds_read_b64_tr_b16 v[114:115], v13 offset:26112
  ds_read_b64_tr_b16 v[116:117], v13 offset:24704
  v_mfma_f32_32x32x16_bf16 v[48:63], v[148:151], v[136:139], v[48:63]
  ds_read_b64_tr_b16 v[118:119], v13 offset:26240
  ds_read_b64_tr_b16 v[120:121], v13 offset:24832
  ds_read_b64_tr_b16 v[122:123], v13 offset:26368
  ds_read_b128 v[108:111], v9 offset:24576
  v_mfma_f32_32x32x16_bf16 v[64:79], v[152:155], v[136:139], v[64:79]
  ds_read_b64_tr_b16 v[124:125], v13 offset:30720
  ds_read_b64_tr_b16 v[126:127], v13 offset:32256
  ds_read_b64_tr_b16 v[128:129], v13 offset:30848
  v_mfma_f32_32x32x16_bf16 v[32:47], v[156:159], v[140:143], v[32:47]
  ds_read_b64_tr_b16 v[130:131], v13 offset:32384
  ds_read_b64_tr_b16 v[132:133], v13 offset:30976
  ds_read_b64_tr_b16 v[134:135], v13 offset:32512
  v_mfma_f32_32x32x16_bf16 v[48:63], v[160:163], v[140:143], v[48:63]
  v_mfma_f32_32x32x16_bf16 v[64:79], v[164:167], v[140:143], v[64:79]
  s_waitcnt lgkmcnt(0)
  v_mfma_f32_32x32x16_bf16 v[32:47], v[112:115], v[104:107], v[32:47]
  ds_read_b128 v[136:139], v10 offset:24576
  ds_read_b64_tr_b16 v[144:145], v13 offset:36864
  ds_read_b64_tr_b16 v[146:147], v13 offset:38400
  ds_read_b64_tr_b16 v[148:149], v13 offset:36992
  v_mfma_f32_32x32x16_bf16 v[48:63], v[116:119], v[104:107], v[48:63]
  ds_read_b64_tr_b16 v[150:151], v13 offset:38528
  ds_read_b64_tr_b16 v[152:153], v13 offset:37120
  ds_read_b64_tr_b16 v[154:155], v13 offset:38656
  ds_read_b128 v[140:143], v11 offset:24576
  v_mfma_f32_32x32x16_bf16 v[64:79], v[120:123], v[104:107], v[64:79]
  ds_read_b64_tr_b16 v[156:157], v13 offset:43008
  ds_read_b64_tr_b16 v[158:159], v13 offset:44544
  ds_read_b64_tr_b16 v[160:161], v13 offset:43136
  v_mfma_f32_32x32x16_bf16 v[32:47], v[124:127], v[108:111], v[32:47]
  ds_read_b64_tr_b16 v[162:163], v13 offset:44672
  ds_read_b64_tr_b16 v[164:165], v13 offset:43264
  ds_read_b64_tr_b16 v[166:167], v13 offset:44800
  v_mfma_f32_32x32x16_bf16 v[48:63], v[128:131], v[108:111], v[48:63]
  v_mfma_f32_32x32x16_bf16 v[64:79], v[132:135], v[108:111], v[64:79]
  s_waitcnt lgkmcnt(0)
  s_cmp_lt_i32 s65, 0
  s_cbranch_scc1 L_last_f
  v_add_u32 v8, s65, v8
  v_add_u32 v9, s65, v9
  v_add_u32 v10, s65, v10
  v_add_u32 v11, s65, v11
  s_barrier
  v_mfma_f32_32x32x16_bf16 v[32:47], v[144:147], v[136:139], v[32:47]
  ds_read_b128 v[104:107], v8 offset:0
  ds_read_b64_tr_b16 v[112:113], v12 offset:0
  ds_read_b64_tr_b16 v[114:115], v12 offset:1536
  ds_read_b64_tr_b16 v[116:117], v12 offset:128
  v_mfma_f32_32x32x16_bf16 v[48:63], v[148:151], v[136:139], v[48:63]
  ds_read_b64_tr_b16 v[118:119], v12 offset:1664
  ds_read_b64_tr_b16 v[120:121], v12 offset:256
  ds_read_b64_tr_b16 v[122:123], v12 offset:1792
  ds_read_b128 v[108:111], v9 offset:0
  v_mfma_f32_32x32x16_bf16 v[64:79], v[152:155], v[136:139], v[64:79]
  ds_read_b64_tr_b16 v[124:125], v12 offset:6144
  ds_read_b64_tr_b16 v[126:127], v12 offset:7680
  ds_read_b64_tr_b16 v[128:129], v12 offset:6272
  v_mfma_f32_32x32x16_bf16 v[32:47], v[156:159], v[140:143], v[32:47]
  ds_read_b64_tr_b16 v[130:131], v12 offset:7808
  ds_read_b64_tr_b16 v[132:133], v12 offset:6400
  ds_read_b64_tr_b16 v[134:135], v12 offset:7936
  v_mfma_f32_32x32x16_bf16 v[48:63], v[160:163], v[140:143], v[48:63]
  v_mfma_f32_32x32x16_bf16 v[64:79], v[164:167], v[140:143], v[64:79]
  s_mov_b32 s65, 0xffff8000
  s_branch L_loop_f
L_last_f:
  v_mfma_f32_32x32x16_bf16 v[32:47], v[144:147], v[136:139], v[32:47]
  v_mfma_f32_32x32x16_bf16 v[48:63], v[148:151], v[136:139], v[48:63]
  v_mfma_f32_32x32x16_bf16 v[64:79], v[152:155], v[136:139], v[64:79]
  v_mfma_f32_32x32x16_bf16 v[32:47], v[156:159], v[140:143], v[32:47]
  v_mfma_f32_32x32x16_bf16 v[48:63], v[160:163], v[140:143], v[48:63]
  v_mfma_f32_32x32x16_bf16 v[64:79], v[164:167], v[140:143], v[64:79]
  s_barrier
  s_add_u32 s32, s26, 6307840
  s_addc_u32 s33, s27, 0
  s_mov_b32 s34, 5636096
  s_mov_b32 s35, 0x20000
  s_lshl_b32 s54, s29, 1
  s_add_u32 s54, s54, s64
  s_add_u32 s55, s31, s63
  s_lshl_b32 s55, s55, 7
  s_add_u32 s54, s54, s55
  s_lshl_b32 s54, s54, 10
  v_lshlrev_b32 v3, 4, v1
  s_nop 4
  v_max_f32 v32, 0, v32
  v_max_f32 v33, 0, v33
  v_max_f32 v34, 0, v34
  v_max_f32 v35, 0, v35
  v_max_f32 v36, 0, v36
  v_max_f32 v37, 0, v37
  v_max_f32 v38, 0, v38
  v_max_f32 v39, 0, v39
  v_max_f32 v40, 0, v40
  v_max_f32 v41, 0, v41
  v_max_f32 v42, 0, v42
  v_max_f32 v43, 0, v43
  v_max_f32 v44, 0, v44
  v_max_f32 v45, 0, v45
  v_max_f32 v46, 0, v46
  v_max_f32 v47, 0, v47
  v_mul_f32 v32, v32, v32
  v_mul_f32 v33, v33, v33
  v_mul_f32 v34, v34, v34
  v_mul_f32 v35, v35, v35
  v_mul_f32 v36, v36, v36
  v_mul_f32 v37, v37, v37
  v_mul_f32 v38, v38, v38
  v_mul_f32 v39, v39, v39
  v_mul_f32 v40, v40, v40
  v_mul_f32 v41, v41, v41
  v_mul_f32 v42, v42, v42
  v_mul_f32 v43, v43, v43
  v_mul_f32 v44, v44, v44
  v_mul_f32 v45, v45, v45
  v_mul_f32 v46, v46, v46
  v_mul_f32 v47, v47, v47
  v_cvt_pk_bf16_f32 v120, v32, v33
  v_cvt_pk_bf16_f32 v121, v34, v35
  v_cvt_pk_bf16_f32 v122, v36, v37
  v_cvt_pk_bf16_f32 v123, v38, v39
  v_cvt_pk_bf16_f32 v124, v40, v41
  v_cvt_pk_bf16_f32 v125, v42, v43
  v_cvt_pk_bf16_f32 v126, v44, v45
  v_cvt_pk_bf16_f32 v127, v46, v47
  v_max_f32 v48, 0, v48
  v_max_f32 v49, 0, v49
  v_max_f32 v50, 0, v50
  v_max_f32 v51, 0, v51
  v_max_f32 v52, 0, v52
  v_max_f32 v53, 0, v53
  v_max_f32 v54, 0, v54
  v_max_f32 v55, 0, v55
  v_max_f32 v56, 0, v56
  v_max_f32 v57, 0, v57
  v_max_f32 v58, 0, v58
  v_max_f32 v59, 0, v59
  v_max_f32 v60, 0, v60
  v_max_f32 v61, 0, v61
  v_max_f32 v62, 0, v62
  v_max_f32 v63, 0, v63
  v_mul_f32 v48, v48, v48
  v_mul_f32 v49, v49, v49
  v_mul_f32 v50, v50, v50
  v_mul_f32 v51, v51, v51
  v_mul_f32 v52, v52, v52
  v_mul_f32 v53, v53, v53
  v_mul_f32 v54, v54, v54
  v_mul_f32 v55, v55, v55
  v_mul_f32 v56, v56, v56
  v_mul_f32 v57, v57, v57
  v_mul_f32 v58, v58, v58
  v_mul_f32 v59, v59, v59
  v_mul_f32 v60, v60, v60
  v_mul_f32 v61, v61, v61
  v_mul_f32 v62, v62, v62
  v_mul_f32 v63, v63, v63
  v_cvt_pk_bf16_f32 v128, v48, v49
  v_cvt_pk_bf16_f32 v129, v50, v51
  v_cvt_pk_bf16_f32 v130, v52, v53
  v_cvt_pk_bf16_f32 v131, v54, v55
  v_cvt_pk_bf16_f32 v132, v56, v57
  v_cvt_pk_bf16_f32 v133, v58, v59
  v_cvt_pk_bf16_f32 v134, v60, v61
  v_cvt_pk_bf16_f32 v135, v62, v63
  v_max_f32 v64, 0, v64
  v_max_f32 v65, 0, v65
  v_max_f32 v66, 0, v66
  v_max_f32 v67, 0, v67
  v_max_f32 v68, 0, v68
  v_max_f32 v69, 0, v69
  v_max_f32 v70, 0, v70
  v_max_f32 v71, 0, v71
  v_max_f32 v72, 0, v72
  v_max_f32 v73, 0, v73
  v_max_f32 v74, 0, v74
  v_max_f32 v75, 0, v75
  v_max_f32 v76, 0, v76
  v_max_f32 v77, 0, v77
  v_max_f32 v78, 0, v78
  v_max_f32 v79, 0, v79
  v_mul_f32 v64, v64, v64
  v_mul_f32 v65, v65, v65
  v_mul_f32 v66, v66, v66
  v_mul_f32 v67, v67, v67
  v_mul_f32 v68, v68, v68
  v_mul_f32 v69, v69, v69
  v_mul_f32 v70, v70, v70
  v_mul_f32 v71, v71, v71
  v_mul_f32 v72, v72, v72
  v_mul_f32 v73, v73, v73
  v_mul_f32 v74, v74, v74
  v_mul_f32 v75, v75, v75
  v_mul_f32 v76, v76, v76
  v_mul_f32 v77, v77, v77
  v_mul_f32 v78, v78, v78
  v_mul_f32 v79, v79, v79
  v_cvt_pk_bf16_f32 v136, v64, v65
  v_cvt_pk_bf16_f32 v137, v66, v67
  v_cvt_pk_bf16_f32 v138, v68, v69
  v_cvt_pk_bf16_f32 v139, v70, v71
  v_cvt_pk_bf16_f32 v140, v72, v73
  v_cvt_pk_bf16_f32 v141, v74, v75
  v_cvt_pk_bf16_f32 v142, v76, v77
  v_cvt_pk_bf16_f32 v143, v78, v79
  s_mov_b32 s83, s54
  s_nop 1
  s_branch L_attn
L_aux:
  s_sub_u32 s67, s3, 4
  s_lshl_b32 s54, s29, 16
  s_add_u32 s32, s4, s54
  s_addc_u32 s33, s5, 0
  s_mov_b32 s34, 65536
  s_mov_b32 s35, 0x20000
  v_lshrrev_b32 v2, 3, v1
  s_lshl_b32 s54, s67, 3
  v_add_u32 v2, s54, v2
  v_lshrrev_b32 v3, 4, v1
  s_and_b32 s54, s67, 1
  s_lshl_b32 s54, s54, 2
  v_add_u32 v3, s54, v3
  v_and_b32 v4, 7, v1
  v_xor_b32 v3, v3, v4
  v_lshlrev_b32 v3, 4, v3
  v_lshl_add_u32 v12, v2, 10, v3
  s_lshl_b32 s68, s67, 10
  s_add_u32 m0, s68, 0
  s_movk_i32 s81, 0
  buffer_load_dwordx4 v12, s[32:35], s81 offen lds
  s_add_u32 m0, s68, 8192
  s_movk_i32 s81, 128
  buffer_load_dwordx4 v12, s[32:35], s81 offen lds
  s_add_u32 m0, s68, 16384
  s_movk_i32 s81, 256
  buffer_load_dwordx4 v12, s[32:35], s81 offen lds
  s_mov_b32 s36, s6
  s_mov_b32 s37, s7
  s_mov_b32 s38, 1572864
  s_mov_b32 s39, 0x20000
  v_add_u32 v2, 0, v1
  v_mul_u32_u24 v3, 171, v2
  v_lshrrev_b32 v3, 12, v3
  v_mul_u32_u24 v4, 24, v3
  v_sub_u32 v2, v2, v4
  v_lshrrev_b32 v4, 3, v2
  v_and_b32 v2, 7, v2
  v_bfe_u32 v5, v3, 1, 1
  v_lshlrev_b32 v5, 2, v5
  v_xor_b32 v2, v2, v5
  v_lshlrev_b32 v2, 4, v2
  v_mul_u32_u24 v5, 3072, v3
  v_lshl_add_u32 v5, v4, 10, v5
  v_add_u32 v13, v5, v2
  v_add_u32 v2, 64, v1
  v_mul_u32_u24 v3, 171, v2
  v_lshrrev_b32 v3, 12, v3
  v_mul_u32_u24 v4, 24, v3
  v_sub_u32 v2, v2, v4
  v_lshrrev_b32 v4, 3, v2
  v_and_b32 v2, 7, v2
  v_bfe_u32 v5, v3, 1, 1
  v_lshlrev_b32 v5, 2, v5
  v_xor_b32 v2, v2, v5
  v_lshlrev_b32 v2, 4, v2
  v_mul_u32_u24 v5, 3072, v3
  v_lshl_add_u32 v5, v4, 10, v5
  v_add_u32 v14, v5, v2
  v_add_u32 v2, 128, v1
  v_mul_u32_u24 v3, 171, v2
  v_lshrrev_b32 v3, 12, v3
  v_mul_u32_u24 v4, 24, v3
  v_sub_u32 v2, v2, v4
  v_lshrrev_b32 v4, 3, v2
  v_and_b32 v2, 7, v2
  v_bfe_u32 v5, v3, 1, 1
  v_lshlrev_b32 v5, 2, v5
  v_xor_b32 v2, v2, v5
  v_lshlrev_b32 v2, 4, v2
  v_mul_u32_u24 v5, 3072, v3
  v_lshl_add_u32 v5, v4, 10, v5
  v_add_u32 v15, v5, v2
  s_mul_i32 s69, s67, 3072
  s_add_u32 s69, s69, 0x10000
  s_lshl_b32 s70, s30, 7
  s_mul_i32 s71, s67, 24576
  s_add_u32 s70, s70, s71
  s_add_u32 s82, s70, 0
  s_add_u32 m0, s69, 0
  s_nop 0
  buffer_load_dwordx4 v13, s[36:39], s82 offen lds
  s_add_u32 m0, s69, 1024
  s_nop 0
  buffer_load_dwordx4 v14, s[36:39], s82 offen lds
  s_add_u32 m0, s69, 2048
  s_nop 0
  buffer_load_dwordx4 v15, s[36:39], s82 offen lds
  s_add_u32 s82, s70, 196608
  s_add_u32 m0, s69, 24576
  s_nop 0
  buffer_load_dwordx4 v13, s[36:39], s82 offen lds
  s_add_u32 m0, s69, 25600
  s_nop 0
  buffer_load_dwordx4 v14, s[36:39], s82 offen lds
  s_add_u32 m0, s69, 26624
  s_nop 0
  buffer_load_dwordx4 v15, s[36:39], s82 offen lds
  s_add_u32 s82, s70, 393216
  s_add_u32 m0, s69, 49152
  s_nop 0
  buffer_load_dwordx4 v13, s[36:39], s82 offen lds
  s_add_u32 m0, s69, 50176
  s_nop 0
  buffer_load_dwordx4 v14, s[36:39], s82 offen lds
  s_add_u32 m0, s69, 51200
  s_nop 0
  buffer_load_dwordx4 v15, s[36:39], s82 offen lds
  s_sub_u32 s66, s67, 4
  s_lshl_b32 s54, s2, 2
  s_or_b32 s54, s54, s66
  s_cmp_lg_u32 s54, 0
  s_cbranch_scc1 L_aux1
  s_mov_b32 s44, s24
  s_mov_b32 s45, s25
  s_mov_b32 s46, 256
  s_mov_b32 s47, 0x20000
  s_memrealtime s[54:55]
  s_waitcnt lgkmcnt(0)
  s_or_b32 s85, s54, 1
  v_mov_b32 v8, s85
  v_mov_b32 v10, 0
  s_mov_b64 exec, 1
  buffer_store_dword v8, v10, s[44:47], 0 offen sc1
  s_mov_b64 exec, -1
L_aux1:
  s_lshl_b32 s54, s29, 6
  s_lshl_b32 s55, s30, 3
  s_add_u32 s54, s54, s55
  s_lshl_b32 s55, s66, 1
  s_add_u32 s86, s54, s55
  s_mov_b32 s40, s12
  s_mov_b32 s41, s13
  s_mov_b32 s42, 1409024
  s_mov_b32 s43, 0x20000
  v_add_u32 v2, 0, v1
  v_mul_u32_u24 v3, 171, v2
  v_lshrrev_b32 v3, 12, v3
  v_mul_u32_u24 v4, 24, v3
  v_sub_u32 v2, v2, v4
  v_lshrrev_b32 v4, 3, v2
  v_and_b32 v2, 7, v2
  v_bfe_u32 v5, v3, 1, 1
  v_lshlrev_b32 v5, 2, v5
  v_xor_b32 v2, v2, v5
  v_lshlrev_b32 v2, 4, v2
  v_mul_u32_u24 v5, 2752, v3
  v_lshl_add_u32 v5, v4, 7, v5
  v_add_u32 v16, v5, v2
  v_add_u32 v2, 64, v1
  v_mul_u32_u24 v3, 171, v2
  v_lshrrev_b32 v3, 12, v3
  v_mul_u32_u24 v4, 24, v3
  v_sub_u32 v2, v2, v4
  v_lshrrev_b32 v4, 3, v2
  v_and_b32 v2, 7, v2
  v_bfe_u32 v5, v3, 1, 1
  v_lshlrev_b32 v5, 2, v5
  v_xor_b32 v2, v2, v5
  v_lshlrev_b32 v2, 4, v2
  v_mul_u32_u24 v5, 2752, v3
  v_lshl_add_u32 v5, v4, 7, v5
  v_add_u32 v17, v5, v2
  v_add_u32 v2, 128, v1
  v_mul_u32_u24 v3, 171, v2
  v_lshrrev_b32 v3, 12, v3
  v_mul_u32_u24 v4, 24, v3
  v_sub_u32 v2, v2, v4
  v_lshrrev_b32 v4, 3, v2
  v_and_b32 v2, 7, v2
  v_bfe_u32 v5, v3, 1, 1
  v_lshlrev_b32 v5, 2, v5
  v_xor_b32 v2, v2, v5
  v_lshlrev_b32 v2, 4, v2
  v_mul_u32_u24 v5, 2752, v3
  v_lshl_add_u32 v5, v4, 7, v5
  v_add_u32 v18, v5, v2
  s_lshl_b32 s71, s31, 6
  s_mul_i32 s72, s67, 22016
  s_add_u32 s71, s71, s72
  s_add_u32 m0, s68, 24576
  s_movk_i32 s81, 384
  s_waitcnt vmcnt(6)
  s_barrier
  buffer_load_dwordx4 v12, s[32:35], s81 offen lds
  s_add_u32 s82, s70, 589824
  s_add_u32 m0, s69, 73728
  s_nop 0
  buffer_load_dwordx4 v13, s[36:39], s82 offen lds
  s_add_u32 m0, s69, 74752
  s_nop 0
  buffer_load_dwordx4 v14, s[36:39], s82 offen lds
  s_add_u32 m0, s69, 75776
  s_nop 0
  buffer_load_dwordx4 v15, s[36:39], s82 offen lds
  s_add_u32 m0, s68, 32768
  s_movk_i32 s81, 512
  s_waitcnt vmcnt(7)
  s_barrier
  buffer_load_dwordx4 v12, s[32:35], s81 offen lds
  s_add_u32 s82, s70, 786432
  s_add_u32 m0, s69, 0
  s_nop 0
  buffer_load_dwordx4 v13, s[36:39], s82 offen lds
  s_add_u32 m0, s69, 1024
  s_nop 0
  buffer_load_dwordx4 v14, s[36:39], s82 offen lds
  s_add_u32 m0, s69, 2048
  s_nop 0
  buffer_load_dwordx4 v15, s[36:39], s82 offen lds
  s_add_u32 m0, s68, 40960
  s_movk_i32 s81, 640
  s_waitcnt vmcnt(8)
  s_barrier
  buffer_load_dwordx4 v12, s[32:35], s81 offen lds
  s_add_u32 s82, s70, 983040
  s_add_u32 m0, s69, 24576
  s_nop 0
  buffer_load_dwordx4 v13, s[36:39], s82 offen lds
  s_add_u32 m0, s69, 25600
  s_nop 0
  buffer_load_dwordx4 v14, s[36:39], s82 offen lds
  s_add_u32 m0, s69, 26624
  s_nop 0
  buffer_load_dwordx4 v15, s[36:39], s82 offen lds
  s_lshl_b32 s54, s86, 10
  s_add_u32 s44, s4, s54
  s_addc_u32 s45, s5, 0
  s_mov_b32 s46, 2048
  s_mov_b32 s47, 0x20000
  v_and_b32 v2, 31, v1
  v_lshlrev_b32 v2, 5, v2
  v_lshrrev_b32 v3, 5, v1
  v_lshl_add_u32 v4, v3, 10, v2
  buffer_load_dwordx4 v[32:35], v4, s[44:47], 0 offen offset:0
  buffer_load_dwordx4 v[36:39], v4, s[44:47], 0 offen offset:16
  s_mov_b32 s44, s20
  s_mov_b32 s45, s21
  s_mov_b32 s46, 1024
  s_mov_b32 s47, 0x20000
  buffer_load_dwordx4 v[40:43], v2, s[44:47], 0 offen offset:0
  buffer_load_dwordx4 v[44:47], v2, s[44:47], 0 offen offset:16
  s_add_u32 m0, s68, 49152
  s_movk_i32 s81, 768
  s_waitcnt vmcnt(12)
  s_barrier
  buffer_load_dwordx4 v12, s[32:35], s81 offen lds
  s_add_u32 s82, s70, 1179648
  s_add_u32 m0, s69, 49152
  s_nop 0
  buffer_load_dwordx4 v13, s[36:39], s82 offen lds
  s_add_u32 m0, s69, 50176
  s_nop 0
  buffer_load_dwordx4 v14, s[36:39], s82 offen lds
  s_add_u32 m0, s69, 51200
  s_nop 0
  buffer_load_dwordx4 v15, s[36:39], s82 offen lds
  s_add_u32 m0, s68, 57344
  s_movk_i32 s81, 896
  s_waitcnt vmcnt(12)
  s_barrier
  buffer_load_dwordx4 v12, s[32:35], s81 offen lds
  s_add_u32 s82, s70, 1376256
  s_add_u32 m0, s69, 73728
  s_nop 0
  buffer_load_dwordx4 v13, s[36:39], s82 offen lds
  s_add_u32 m0, s69, 74752
  s_nop 0
  buffer_load_dwordx4 v14, s[36:39], s82 offen lds
  s_add_u32 m0, s69, 75776
  s_nop 0
  buffer_load_dwordx4 v15, s[36:39], s82 offen lds
  s_mov_b32 s44, s24
  s_mov_b32 s45, s25
  s_mov_b32 s46, 256
  s_mov_b32 s47, 0x20000
  v_mov_b32 v10, 0
  buffer_load_dword v8, v10, s[44:47], 0 offen sc1
  s_add_u32 s82, s71, 0
  s_add_u32 m0, s69, 0
  s_waitcnt vmcnt(13)
  s_barrier
  buffer_load_dwordx4 v16, s[40:43], s82 offen lds
  s_add_u32 m0, s69, 1024
  s_nop 0
  buffer_load_dwordx4 v17, s[40:43], s82 offen lds
  s_add_u32 m0, s69, 2048
  s_nop 0
  buffer_load_dwordx4 v18, s[40:43], s82 offen lds
  s_add_u32 s82, s71, 176128
  s_add_u32 m0, s69, 24576
  s_waitcnt vmcnt(8)
  s_barrier
  buffer_load_dwordx4 v16, s[40:43], s82 offen lds
  s_add_u32 m0, s69, 25600
  s_nop 0
  buffer_load_dwordx4 v17, s[40:43], s82 offen lds
  s_add_u32 m0, s69, 26624
  s_nop 0
  buffer_load_dwordx4 v18, s[40:43], s82 offen lds
  v_mov_b32 v24, 0
  v_dot2c_f32_bf16 v24, v32, v40
  v_dot2c_f32_bf16 v24, v33, v41
  v_dot2c_f32_bf16 v24, v34, v42
  v_dot2c_f32_bf16 v24, v35, v43
  v_dot2c_f32_bf16 v24, v36, v44
  v_dot2c_f32_bf16 v24, v37, v45
  v_dot2c_f32_bf16 v24, v38, v46
  v_dot2c_f32_bf16 v24, v39, v47
  s_nop 3
  v_add_f32_dpp v24, v24, v24 row_shr:1 row_mask:0xf bank_mask:0xf
  s_nop 1
  v_add_f32_dpp v24, v24, v24 row_shr:2 row_mask:0xf bank_mask:0xf
  s_nop 1
  v_add_f32_dpp v24, v24, v24 row_shr:4 row_mask:0xf bank_mask:0xf
  s_nop 1
  v_add_f32_dpp v24, v24, v24 row_shr:8 row_mask:0xf bank_mask:0xf
  s_nop 1
  v_add_f32_dpp v24, v24, v24 row_bcast:15 row_mask:0xa bank_mask:0xf
  s_nop 1
  v_cvt_pk_bf16_f32 v24, v24, v24
  v_and_b32 v24, 0xffff0000, v24
  v_mul_f32 v24, 0xbfb8aa3b, v24
  v_exp_f32 v24, v24
  s_nop 0
  v_add_f32 v24, 1.0, v24
  v_rcp_f32 v24, v24
  s_nop 0
  v_cvt_pk_bf16_f32 v24, v24, v24
  v_and_b32 v24, 0xffff0000, v24
  s_add_u32 s44, s26, 12582912
  s_addc_u32 s45, s27, 0
  s_mov_b32 s46, 8192
  s_mov_b32 s47, 0x20000
  s_lshl_b32 s54, s86, 2
  v_lshrrev_b32 v3, 5, v1
  v_lshlrev_b32 v3, 2, v3
  s_mov_b32 s52, 0x80000000
  s_mov_b32 s53, 0x80000000
  s_mov_b64 exec, s[52:53]
  buffer_store_dword v24, v3, s[44:47], s54 offen sc1
  s_mov_b64 exec, -1
  s_add_u32 s82, s71, 352256
  s_add_u32 m0, s69, 49152
  s_waitcnt vmcnt(8)
  s_barrier
  buffer_load_dwordx4 v16, s[40:43], s82 offen lds
  s_add_u32 m0, s69, 50176
  s_nop 0
  buffer_load_dwordx4 v17, s[40:43], s82 offen lds
  s_add_u32 m0, s69, 51200
  s_nop 0
  buffer_load_dwordx4 v18, s[40:43], s82 offen lds
  s_add_u32 s82, s71, 528384
  s_add_u32 m0, s69, 73728
  s_waitcnt vmcnt(7)
  s_barrier
  buffer_load_dwordx4 v16, s[40:43], s82 offen lds
  s_add_u32 m0, s69, 74752
  s_nop 0
  buffer_load_dwordx4 v17, s[40:43], s82 offen lds
  s_add_u32 m0, s69, 75776
  s_nop 0
  buffer_load_dwordx4 v18, s[40:43], s82 offen lds
  v_readfirstlane_b32 s60, v8
  s_mov_b32 s50, 0x40000
L_nonce:
  s_cmp_lg_u32 s60, 0
  s_cbranch_scc1 L_nonce_ok
  s_sub_u32 s50, s50, 1
  s_cmp_eq_u32 s50, 0
  s_cbranch_scc1 L_nonce_ok
  s_mov_b32 s44, s24
  s_mov_b32 s45, s25
  s_mov_b32 s46, 256
  s_mov_b32 s47, 0x20000
  buffer_load_dword v8, v10, s[44:47], 0 offen sc1
  s_waitcnt vmcnt(0)
  v_readfirstlane_b32 s60, v8
  s_branch L_nonce
L_nonce_ok:
  s_add_u32 s82, s71, 704512
  s_add_u32 m0, s69, 0
  s_waitcnt vmcnt(7)
  s_barrier
  buffer_load_dwordx4 v16, s[40:43], s82 offen lds
  s_add_u32 m0, s69, 1024
  s_nop 0
  buffer_load_dwordx4 v17, s[40:43], s82 offen lds
  s_add_u32 m0, s69, 2048
  s_nop 0
  buffer_load_dwordx4 v18, s[40:43], s82 offen lds
  s_add_u32 s82, s71, 880640
  s_add_u32 m0, s69, 24576
  s_waitcnt vmcnt(6)
  s_barrier
  buffer_load_dwordx4 v16, s[40:43], s82 offen lds
  s_add_u32 m0, s69, 25600
  s_nop 0
  buffer_load_dwordx4 v17, s[40:43], s82 offen lds
  s_add_u32 m0, s69, 26624
  s_nop 0
  buffer_load_dwordx4 v18, s[40:43], s82 offen lds
  s_cmp_lg_u32 s66, 1
  s_cbranch_scc1 L_aux3
  v_lshlrev_b32 v10, 2, v1
  v_mov_b32 v9, 0
  ds_write_b32 v10, v9
  s_waitcnt lgkmcnt(0)
  v_mov_b32 v10, 0
L_aux3:
  s_add_u32 s82, s71, 1056768
  s_add_u32 m0, s69, 49152
  s_waitcnt vmcnt(6)
  s_barrier
  buffer_load_dwordx4 v16, s[40:43], s82 offen lds
  s_add_u32 m0, s69, 50176
  s_nop 0
  buffer_load_dwordx4 v17, s[40:43], s82 offen lds
  s_add_u32 m0, s69, 51200
  s_nop 0
  buffer_load_dwordx4 v18, s[40:43], s82 offen lds
  s_cmp_lg_u32 s66, 0
  s_cbranch_scc1 L_aux2
  s_add_u32 s44, s26, 16785408
  s_addc_u32 s45, s27, 0
  s_mov_b32 s46, 16384
  s_mov_b32 s47, 0x20000
  s_lshl_b32 s54, s30, 7
  s_lshl_b32 s55, s29, 2
  s_add_u32 s54, s54, s55
  s_add_u32 s54, s54, 0
  v_mov_b32 v8, s60
  v_mov_b32 v10, 0
  s_mov_b64 exec, 1
  buffer_store_dword v8, v10, s[44:47], s54 offen sc1
  s_mov_b64 exec, -1
L_aux2:
  s_add_u32 s82, s71, 1232896
  s_add_u32 m0, s69, 73728
  s_waitcnt vmcnt(6)
  s_barrier
  buffer_load_dwordx4 v16, s[40:43], s82 offen lds
  s_add_u32 m0, s69, 74752
  s_nop 0
  buffer_load_dwordx4 v17, s[40:43], s82 offen lds
  s_add_u32 m0, s69, 75776
  s_nop 0
  buffer_load_dwordx4 v18, s[40:43], s82 offen lds
  s_cmp_lg_u32 s66, 0
  s_cbranch_scc1 L_aux4
  v_mov_b32 v9, 128
  v_mov_b32 v11, s60
  ds_write_b32 v9, v11
  s_waitcnt lgkmcnt(0)
L_aux4:
  s_waitcnt vmcnt(6)
  s_barrier
  s_waitcnt vmcnt(3)
  s_barrier
  s_add_u32 s40, s26, 16785408
  s_addc_u32 s41, s27, 0
  s_mov_b32 s42, 16384
  s_mov_b32 s43, 0x20000
  s_lshr_b32 s88, s61, 2
  s_lshl_b32 s88, s88, 7
  s_add_u32 s88, s88, 0
  v_lshlrev_b32 v9, 2, v1
  s_mov_b32 exec_hi, 0
  buffer_load_dword v11, v9, s[40:43], s88 offen sc1
  s_mov_b64 exec, -1
  v_lshlrev_b32 v4, 4, v1
  s_lshl_b32 s54, s61, 16
  s_add_u32 s55, s54, 2105344
  s_add_u32 s32, s26, s55
  s_addc_u32 s33, s27, 0
  s_mov_b32 s34, 65536
  s_mov_b32 s35, 0x20000
  s_add_u32 s55, s54, 4206592
  s_add_u32 s36, s26, s55
  s_addc_u32 s37, s27, 0
  s_mov_b32 s38, 65536
  s_mov_b32 s39, 0x20000
  s_add_u32 s55, s54, 4096
  s_add_u32 s44, s26, s55
  s_addc_u32 s45, s27, 0
  s_mov_b32 s46, 65536
  s_mov_b32 s47, 0x20000
  s_lshl_b32 s54, s62, 3
  s_lshl_b32 s55, s66, 1
  s_add_u32 s54, s54, s55
  s_lshl_b32 s54, s54, 10
  s_lshl_b32 s55, s66, 11
  s_add_u32 s55, s55, 132096
  s_waitcnt vmcnt(1)
  s_barrier
  s_mov_b32 exec_hi, 0
  buffer_load_dword v26, v9, s[40:43], s88 offen sc1
  s_mov_b64 exec, -1
  s_barrier
  s_mov_b32 s67, s66
  s_setprio 3
  s_mov_b32 exec_hi, 0
  s_waitcnt vmcnt(1)
  v_cmp_ne_u32 vcc, s60, v11
  s_cbranch_vccz L_aux5a
  s_waitcnt vmcnt(0)
  v_cmp_ne_u32 vcc, s60, v26
L_aux5a:
  s_mov_b64 exec, -1
  s_cbranch_vccz L_aux5
  s_mov_b32 exec_lo, 0xffffffff
  s_mov_b32 exec_hi, 0
  s_mov_b32 s50, 0x40000
L_poll2:
  buffer_load_dword v11, v9, s[40:43], s88 offen sc1
  s_waitcnt vmcnt(0)
  v_cmp_ne_u32 vcc, s60, v11
  s_cbranch_vccz L_polld3
  s_sub_u32 s50, s50, 1
  s_cmp_eq_u32 s50, 0
  s_cbranch_scc1 L_polld3
  s_sleep 2
  s_branch L_poll2
L_polld3:
  s_mov_b64 exec, -1
L_aux5:
  s_add_u32 m0, s55, 0
  s_add_u32 s56, s54, 0
  buffer_load_dwordx4 v4, s[44:47], s56 offen sc1 lds
  s_add_u32 m0, s55, 1024
  s_add_u32 s56, s54, 1024
  buffer_load_dwordx4 v4, s[44:47], s56 offen sc1 lds
  s_lshl_b32 s54, s67, 10
  s_add_u32 s55, s54, 0
  s_add_u32 m0, s55, 1024
  s_add_u32 s56, s55, 66560
  buffer_load_dwordx4 v4, s[32:35], s55 offen sc1 lds
  s_mov_b32 m0, s56
  s_nop 0
  buffer_load_dwordx4 v4, s[36:39], s55 offen sc1 lds
  s_add_u32 s55, s54, 4096
  s_add_u32 m0, s55, 1024
  s_add_u32 s56, s55, 66560
  buffer_load_dwordx4 v4, s[32:35], s55 offen sc1 lds
  s_mov_b32 m0, s56
  s_nop 0
  buffer_load_dwordx4 v4, s[36:39], s55 offen sc1 lds
  s_waitcnt vmcnt(0)
  v_mov_b32 v8, 0
  v_mov_b32 v9, 1
  s_mov_b64 exec, 1
  ds_add_u32 v8, v9
  s_mov_b64 exec, -1
  s_add_u32 s55, s54, 8192
  s_add_u32 m0, s55, 1024
  s_add_u32 s56, s55, 66560
  buffer_load_dwordx4 v4, s[32:35], s55 offen sc1 lds
  s_mov_b32 m0, s56
  s_nop 0
  buffer_load_dwordx4 v4, s[36:39], s55 offen sc1 lds
  s_add_u32 s55, s54, 12288
  s_add_u32 m0, s55, 1024
  s_add_u32 s56, s55, 66560
  buffer_load_dwordx4 v4, s[32:35], s55 offen sc1 lds
  s_mov_b32 m0, s56
  s_nop 0
  buffer_load_dwordx4 v4, s[36:39], s55 offen sc1 lds
  s_add_u32 s55, s54, 16384
  s_add_u32 m0, s55, 1024
  s_add_u32 s56, s55, 66560
  buffer_load_dwordx4 v4, s[32:35], s55 offen sc1 lds
  s_mov_b32 m0, s56
  s_nop 0
  buffer_load_dwordx4 v4, s[36:39], s55 offen sc1 lds
  s_add_u32 s55, s54, 20480
  s_add_u32 m0, s55, 1024
  s_add_u32 s56, s55, 66560
  buffer_load_dwordx4 v4, s[32:35], s55 offen sc1 lds
  s_mov_b32 m0, s56
  s_nop 0
  buffer_load_dwordx4 v4, s[36:39], s55 offen sc1 lds
  s_add_u32 s55, s54, 24576
  s_add_u32 m0, s55, 1024
  s_add_u32 s56, s55, 66560
  buffer_load_dwordx4 v4, s[32:35], s55 offen sc1 lds
  s_mov_b32 m0, s56
  s_nop 0
  buffer_load_dwordx4 v4, s[36:39], s55 offen sc1 lds
  s_add_u32 s55, s54, 28672
  s_add_u32 m0, s55, 1024
  s_add_u32 s56, s55, 66560
  buffer_load_dwordx4 v4, s[32:35], s55 offen sc1 lds
  s_mov_b32 m0, s56
  s_nop 0
  buffer_load_dwordx4 v4, s[36:39], s55 offen sc1 lds
  s_add_u32 s55, s54, 32768
  s_add_u32 m0, s55, 1024
  s_add_u32 s56, s55, 66560
  buffer_load_dwordx4 v4, s[32:35], s55 offen sc1 lds
  s_mov_b32 m0, s56
  s_nop 0
  buffer_load_dwordx4 v4, s[36:39], s55 offen sc1 lds
  s_add_u32 s55, s54, 36864
  s_add_u32 m0, s55, 1024
  s_add_u32 s56, s55, 66560
  buffer_load_dwordx4 v4, s[32:35], s55 offen sc1 lds
  s_mov_b32 m0, s56
  s_nop 0
  buffer_load_dwordx4 v4, s[36:39], s55 offen sc1 lds
  s_add_u32 s55, s54, 40960
  s_add_u32 m0, s55, 1024
  s_add_u32 s56, s55, 66560
  buffer_load_dwordx4 v4, s[32:35], s55 offen sc1 lds
  s_mov_b32 m0, s56
  s_nop 0
  buffer_load_dwordx4 v4, s[36:39], s55 offen sc1 lds
  s_add_u32 s55, s54, 45056
  s_add_u32 m0, s55, 1024
  s_add_u32 s56, s55, 66560
  buffer_load_dwordx4 v4, s[32:35], s55 offen sc1 lds
  s_mov_b32 m0, s56
  s_nop 0
  buffer_load_dwordx4 v4, s[36:39], s55 offen sc1 lds
  s_add_u32 s55, s54, 49152
  s_add_u32 m0, s55, 1024
  s_add_u32 s56, s55, 66560
  buffer_load_dwordx4 v4, s[32:35], s55 offen sc1 lds
  s_mov_b32 m0, s56
  s_nop 0
  buffer_load_dwordx4 v4, s[36:39], s55 offen sc1 lds
  s_add_u32 s55, s54, 53248
  s_add_u32 m0, s55, 1024
  s_add_u32 s56, s55, 66560
  buffer_load_dwordx4 v4, s[32:35], s55 offen sc1 lds
  s_mov_b32 m0, s56
  s_nop 0
  buffer_load_dwordx4 v4, s[36:39], s55 offen sc1 lds
  s_add_u32 s55, s54, 57344
  s_add_u32 m0, s55, 1024
  s_add_u32 s56, s55, 66560
  buffer_load_dwordx4 v4, s[32:35], s55 offen sc1 lds
  s_mov_b32 m0, s56
  s_nop 0
  buffer_load_dwordx4 v4, s[36:39], s55 offen sc1 lds
  s_add_u32 s55, s54, 61440
  s_add_u32 m0, s55, 1024
  s_add_u32 s56, s55, 66560
  buffer_load_dwordx4 v4, s[32:35], s55 offen sc1 lds
  s_mov_b32 m0, s56
  s_nop 0
  buffer_load_dwordx4 v4, s[36:39], s55 offen sc1 lds
  s_lshr_b32 s53, s2, 3
  s_mov_b32 s32, s16
  s_mov_b32 s33, s17
  s_mov_b32 s34, 1409024
  s_mov_b32 s35, 0x20000
  s_mov_b32 s36, s8
  s_mov_b32 s37, s9
  s_mov_b32 s38, 524288
  s_mov_b32 s39, 0x20000
  s_mul_i32 s54, s53, 44032
  s_lshl_b32 s55, s67, 10
  s_add_u32 s54, s54, s55
  s_waitcnt vmcnt(0)
  v_mov_b32 v8, 0
  v_mov_b32 v9, 1
  s_mov_b64 exec, 1
  ds_add_u32 v8, v9
  s_mov_b64 exec, -1
  v_lshlrev_b32 v10, 7, v1
  s_lshl_b32 s55, s67, 13
  s_mul_i32 s54, s53, 44032
  s_add_u32 s54, s54, s55
  buffer_load_dword v40, v10, s[32:35], s54 offen
  s_add_u32 s54, s54, 32768
  buffer_load_dword v41, v10, s[32:35], s54 offen
  s_lshl_b32 s54, s53, 14
  s_lshl_b32 s55, s67, 12
  s_add_u32 s54, s54, s55
  s_mov_b32 exec_hi, 0
  buffer_load_dword v42, v10, s[36:39], s54 offen
  s_mov_b64 exec, -1
  s_cmp_lg_u32 s67, 0
  s_cbranch_scc1 L_f1
  v_mov_b32 v8, 16
  s_mov_b32 s50, 0x400000
L_spin4:
  ds_read_b32 v9, v8
  s_waitcnt lgkmcnt(0)
  v_readfirstlane_b32 s51, v9
  s_sub_u32 s50, s50, 1
  s_cmp_ge_u32 s51, 4
  s_cbranch_scc1 L_spind5
  s_cmp_eq_u32 s50, 0
  s_cbranch_scc1 L_spind5
  s_sleep 1
  s_branch L_spin4
L_spind5:
  v_mov_b32 v8, 0
  s_mov_b32 s50, 0x400000
L_spin6:
  ds_read_b32 v9, v8
  s_waitcnt lgkmcnt(0)
  v_readfirstlane_b32 s51, v9
  s_sub_u32 s50, s50, 1
  s_cmp_ge_u32 s51, 8
  s_cbranch_scc1 L_spind7
  s_cmp_eq_u32 s50, 0
  s_cbranch_scc1 L_spind7
  s_sleep 1
  s_branch L_spin6
L_spind7:
  s_lshl_b32 s54, s29, 7
  s_lshl_b32 s55, s30, 2
  s_add_u32 s54, s54, s55
  s_add_u32 s54, s54, 4096
  v_mov_b32 v8, s60
  v_mov_b32 v10, 0
  s_mov_b64 exec, 1
  buffer_store_dword v8, v10, s[40:43], s54 offen sc1
  s_mov_b64 exec, -1
  s_lshl_b32 s54, s61, 7
  s_add_u32 s54, s54, 4096
  v_lshlrev_b32 v8, 2, v1
  s_mov_b32 exec_lo, 0xff
  s_mov_b32 exec_hi, 0
  s_mov_b32 s50, 0x40000
L_poll8:
  buffer_load_dword v9, v8, s[40:43], s54 offen sc1
  s_waitcnt vmcnt(0)
  v_cmp_ne_u32 vcc, s60, v9
  s_cbranch_vccz L_polld9
  s_sub_u32 s50, s50, 1
  s_cmp_eq_u32 s50, 0
  s_cbranch_scc1 L_polld9
  s_sleep 8
  s_branch L_poll8
L_polld9:
  s_mov_b64 exec, -1
  v_mov_b32 v8, 4
  v_mov_b32 v9, 1
  s_mov_b64 exec, 1
  ds_add_u32 v8, v9
  s_mov_b64 exec, -1
  s_branch L_f2
L_f1:
  v_mov_b32 v8, 4
  s_mov_b32 s50, 0x400000
L_spin10:
  ds_read_b32 v9, v8
  s_waitcnt lgkmcnt(0)
  v_readfirstlane_b32 s51, v9
  s_sub_u32 s50, s50, 1
  s_cmp_ge_u32 s51, 1
  s_cbranch_scc1 L_spind11
  s_cmp_eq_u32 s50, 0
  s_cbranch_scc1 L_spind11
  s_sleep 1
  s_branch L_spin10
L_spind11:
L_f2:
  v_mov_b32 v8, 12
  s_mov_b32 s50, 0x400000
L_spin12:
  ds_read_b32 v9, v8
  s_waitcnt lgkmcnt(0)
  v_readfirstlane_b32 s51, v9
  s_sub_u32 s50, s50, 1
  s_cmp_ge_u32 s51, 8
  s_cbranch_scc1 L_spind13
  s_cmp_eq_u32 s50, 0
  s_cbranch_scc1 L_spind13
  s_sleep 1
  s_branch L_spin12
L_spind13:
  s_mov_b32 s32, s16
  s_mov_b32 s33, s17
  s_mov_b32 s34, 1409024
  s_mov_b32 s35, 0x20000
  s_add_u32 s36, s26, 6307840
  s_addc_u32 s37, s27, 0
  s_mov_b32 s38, 5636096
  s_mov_b32 s39, 0x20000
  v_lshlrev_b32 v2, 4, v1
  v_lshrrev_b32 v8, 3, v1
  v_mul_u32_u24 v3, 1024, v8
  v_bfe_u32 v8, v1, 4, 1
  v_lshlrev_b32 v8, 2, v8
  v_and_b32 v9, 7, v1
  v_xor_b32 v8, v8, v9
  v_lshl_add_u32 v3, v8, 4, v3
  s_lshl_b32 s54, s62, 7
  v_add_u32 v3, s54, v3
  v_bfe_u32 v8, v1, 2, 2
  v_lshrrev_b32 v9, 5, v1
  v_mul_u32_u24 v9, 4, v9
  v_add_u32 v8, v8, v9
  v_mul_u32_u24 v4, 128, v8
  v_bfe_u32 v8, v1, 4, 1
  v_lshlrev_b32 v8, 1, v8
  v_bfe_u32 v9, v1, 1, 1
  v_add_u32 v8, v8, v9
  v_bfe_u32 v9, v1, 3, 1
  v_lshlrev_b32 v9, 2, v9
  v_xor_b32 v8, v8, v9
  v_lshl_add_u32 v4, v8, 4, v4
  v_and_b32 v8, 1, v1
  v_lshl_add_u32 v4, v8, 3, v4
  s_mul_i32 s68, s67, 6144
  s_add_u32 s68, s68, 132096
  v_add_u32 v4, s68, v4
  v_xor_b32 v5, 64, v4
  s_mul_i32 s54, s67, 24
  s_lshl_b32 s70, s54, 14
  s_lshl_b32 s71, s54, 16
  s_lshl_b32 s55, s61, 11
  s_add_u32 s71, s71, s55
  v_mov_b32 v104, 0
  v_mov_b32 v105, 0
  v_mov_b32 v106, 0
  v_mov_b32 v107, 0
  v_mov_b32 v108, 0
  v_mov_b32 v109, 0
  v_mov_b32 v110, 0
  v_mov_b32 v111, 0
  v_mov_b32 v112, 0
  v_mov_b32 v113, 0
  v_mov_b32 v114, 0
  v_mov_b32 v115, 0
  v_mov_b32 v116, 0
  v_mov_b32 v117, 0
  v_mov_b32 v118, 0
  v_mov_b32 v119, 0
  v_mov_b32 v120, 0
  v_mov_b32 v121, 0
  v_mov_b32 v122, 0
  v_mov_b32 v123, 0
  v_mov_b32 v124, 0
  v_mov_b32 v125, 0
  v_mov_b32 v126, 0
  v_mov_b32 v127, 0
  v_mov_b32 v128, 0
  v_mov_b32 v129, 0
  v_mov_b32 v130, 0
  v_mov_b32 v131, 0
  v_mov_b32 v132, 0
  v_mov_b32 v133, 0
  v_mov_b32 v134, 0
  v_mov_b32 v135, 0
  v_mov_b32 v136, 0
  v_mov_b32 v137, 0
  v_mov_b32 v138, 0
  v_mov_b32 v139, 0
  v_mov_b32 v140, 0
  v_mov_b32 v141, 0
  v_mov_b32 v142, 0
  v_mov_b32 v143, 0
  v_mov_b32 v144, 0
  v_mov_b32 v145, 0
  v_mov_b32 v146, 0
  v_mov_b32 v147, 0
  v_mov_b32 v148, 0
  v_mov_b32 v149, 0
  v_mov_b32 v150, 0
  v_mov_b32 v151, 0
  v_mov_b32 v152, 0
  v_mov_b32 v153, 0
  v_mov_b32 v154, 0
  v_mov_b32 v155, 0
  v_mov_b32 v156, 0
  v_mov_b32 v157, 0
  v_mov_b32 v158, 0
  v_mov_b32 v159, 0
  v_mov_b32 v160, 0
  v_mov_b32 v161, 0
  v_mov_b32 v162, 0
  v_mov_b32 v163, 0
  v_mov_b32 v164, 0
  v_mov_b32 v165, 0
  v_mov_b32 v166, 0
  v_mov_b32 v167, 0
  s_waitcnt vmcnt(0)
  s_cmp_eq_u32 s67, 3
  s_cselect_b32 s72, 5, 8
  s_add_u32 m0, s68, 0
  s_add_u32 s69, s70, 8192
  buffer_load_dwordx4 v3, s[32:35], s70 offen lds
  s_add_u32 m0, s68, 1024
  s_add_u32 s70, s70, 16384
  buffer_load_dwordx4 v3, s[32:35], s69 offen lds
  buffer_load_dwordx4 v[40:43], v2, s[36:39], s71 offen sc1
  buffer_load_dwordx4 v[44:47], v2, s[36:39], s71 offen offset:1024 sc1
  s_add_u32 s71, s71, 65536
  s_add_u32 m0, s68, 2048
  s_add_u32 s69, s70, 8192
  buffer_load_dwordx4 v3, s[32:35], s70 offen lds
  s_add_u32 m0, s68, 3072
  s_add_u32 s70, s70, 16384
  buffer_load_dwordx4 v3, s[32:35], s69 offen lds
  buffer_load_dwordx4 v[48:51], v2, s[36:39], s71 offen sc1
  buffer_load_dwordx4 v[52:55], v2, s[36:39], s71 offen offset:1024 sc1
  s_add_u32 s71, s71, 65536
  s_add_u32 m0, s68, 4096
  s_add_u32 s69, s70, 8192
  buffer_load_dwordx4 v3, s[32:35], s70 offen lds
  s_add_u32 m0, s68, 5120
  s_add_u32 s70, s70, 16384
  buffer_load_dwordx4 v3, s[32:35], s69 offen lds
  buffer_load_dwordx4 v[56:59], v2, s[36:39], s71 offen sc1
  buffer_load_dwordx4 v[60:63], v2, s[36:39], s71 offen offset:1024 sc1
  s_add_u32 s71, s71, 65536
  s_setprio 0
L_floop:
  s_waitcnt vmcnt(8)
  ds_read_b64_tr_b16 v[24:25], v4 offset:0
  ds_read_b64_tr_b16 v[26:27], v4 offset:1024
  ds_read_b64_tr_b16 v[28:29], v5 offset:0
  ds_read_b64_tr_b16 v[30:31], v5 offset:1024
  s_waitcnt lgkmcnt(0)
  v_mfma_f32_32x32x16_bf16 v[104:119], v[24:27], v[40:43], v[104:119]
  s_add_u32 m0, s68, 0
  s_add_u32 s69, s70, 8192
  buffer_load_dwordx4 v3, s[32:35], s70 offen lds
  v_mfma_f32_32x32x16_bf16 v[136:151], v[28:31], v[40:43], v[136:151]
  s_add_u32 m0, s68, 1024
  s_add_u32 s70, s70, 16384
  buffer_load_dwordx4 v3, s[32:35], s69 offen lds
  v_mfma_f32_32x32x16_bf16 v[120:135], v[24:27], v[44:47], v[120:135]
  buffer_load_dwordx4 v[40:43], v2, s[36:39], s71 offen sc1
  v_mfma_f32_32x32x16_bf16 v[152:167], v[28:31], v[44:47], v[152:167]
  buffer_load_dwordx4 v[44:47], v2, s[36:39], s71 offen offset:1024 sc1
  s_add_u32 s71, s71, 65536
  s_waitcnt vmcnt(8)
  ds_read_b64_tr_b16 v[24:25], v4 offset:2048
  ds_read_b64_tr_b16 v[26:27], v4 offset:3072
  ds_read_b64_tr_b16 v[28:29], v5 offset:2048
  ds_read_b64_tr_b16 v[30:31], v5 offset:3072
  s_waitcnt lgkmcnt(0)
  v_mfma_f32_32x32x16_bf16 v[104:119], v[24:27], v[48:51], v[104:119]
  s_add_u32 m0, s68, 2048
  s_add_u32 s69, s70, 8192
  buffer_load_dwordx4 v3, s[32:35], s70 offen lds
  v_mfma_f32_32x32x16_bf16 v[136:151], v[28:31], v[48:51], v[136:151]
  s_add_u32 m0, s68, 3072
  s_add_u32 s70, s70, 16384
  buffer_load_dwordx4 v3, s[32:35], s69 offen lds
  v_mfma_f32_32x32x16_bf16 v[120:135], v[24:27], v[52:55], v[120:135]
  buffer_load_dwordx4 v[48:51], v2, s[36:39], s71 offen sc1
  v_mfma_f32_32x32x16_bf16 v[152:167], v[28:31], v[52:55], v[152:167]
  buffer_load_dwordx4 v[52:55], v2, s[36:39], s71 offen offset:1024 sc1
  s_add_u32 s71, s71, 65536
  s_waitcnt vmcnt(8)
  ds_read_b64_tr_b16 v[24:25], v4 offset:4096
  ds_read_b64_tr_b16 v[26:27], v4 offset:5120
  ds_read_b64_tr_b16 v[28:29], v5 offset:4096
  ds_read_b64_tr_b16 v[30:31], v5 offset:5120
  s_waitcnt lgkmcnt(0)
  v_mfma_f32_32x32x16_bf16 v[104:119], v[24:27], v[56:59], v[104:119]
  s_add_u32 m0, s68, 4096
  s_add_u32 s69, s70, 8192
  buffer_load_dwordx4 v3, s[32:35], s70 offen lds
  v_mfma_f32_32x32x16_bf16 v[136:151], v[28:31], v[56:59], v[136:151]
  s_add_u32 m0, s68, 5120
  s_add_u32 s70, s70, 16384
  buffer_load_dwordx4 v3, s[32:35], s69 offen lds
  v_mfma_f32_32x32x16_bf16 v[120:135], v[24:27], v[60:63], v[120:135]
  buffer_load_dwordx4 v[56:59], v2, s[36:39], s71 offen sc1
  v_mfma_f32_32x32x16_bf16 v[152:167], v[28:31], v[60:63], v[152:167]
  buffer_load_dwordx4 v[60:63], v2, s[36:39], s71 offen offset:1024 sc1
  s_add_u32 s71, s71, 65536
  s_sub_u32 s72, s72, 1
  s_cmp_lg_u32 s72, 0
  s_cbranch_scc1 L_floop
L_fskip:
  s_setprio 3
  s_waitcnt vmcnt(0)
  v_mov_b32 v8, 20
  v_mov_b32 v9, 1
  s_mov_b64 exec, 1
  ds_add_u32 v8, v9
  s_mov_b64 exec, -1
  s_add_u32 s32, s26, 12582912
  s_addc_u32 s33, s27, 0
  s_mov_b32 s34, 8192
  s_mov_b32 s35, 0x20000
  s_mov_b32 s36, s18
  s_mov_b32 s37, s19
  s_mov_b32 s38, 1024
  s_mov_b32 s39, 0x20000
  s_and_b32 s73, s67, 1
  s_lshr_b32 s74, s67, 1
  s_lshl_b32 s75, s61, 6
  s_lshl_b32 s54, s73, 5
  s_add_u32 s75, s75, s54
  s_lshl_b32 s54, s75, 2
  v_and_b32 v8, 31, v1
  v_lshlrev_b32 v8, 2, v8
  buffer_load_dword v39, v8, s[32:35], s54 offen sc1
  s_lshl_b32 s54, s62, 6
  s_lshl_b32 s55, s74, 5
  s_add_u32 s54, s54, s55
  s_lshl_b32 s54, s54, 1
  v_lshrrev_b32 v8, 5, v1
  v_lshlrev_b32 v8, 3, v8
  buffer_load_dwordx2 v[42:43], v8, s[36:39], s54 offen offset:0
  buffer_load_dwordx2 v[44:45], v8, s[36:39], s54 offen offset:16
  buffer_load_dwordx2 v[46:47], v8, s[36:39], s54 offen offset:32
  buffer_load_dwordx2 v[48:49], v8, s[36:39], s54 offen offset:48
  v_bfe_u32 v32, v1, 2, 2
  v_lshrrev_b32 v33, 5, v1
  v_mul_u32_u24 v33, 4, v33
  v_add_u32 v32, v32, v33
  v_mul_u32_u24 v4, 128, v32
  v_bfe_u32 v32, v1, 4, 1
  v_lshlrev_b32 v32, 1, v32
  v_bfe_u32 v33, v1, 1, 1
  v_add_u32 v32, v32, v33
  v_bfe_u32 v33, v1, 3, 1
  v_lshlrev_b32 v33, 2, v33
  v_xor_b32 v32, v32, v33
  v_lshl_add_u32 v4, v32, 4, v4
  v_and_b32 v32, 1, v1
  v_lshl_add_u32 v4, v32, 3, v4
  s_lshl_b32 s54, s74, 6
  v_xor_b32 v4, s54, v4
  v_add_u32 v4, 1024, v4
  s_lshl_b32 s54, s73, 15
  s_add_u32 s54, s54, 66560
  v_add_u32 v5, s54, v2
  s_lshl_b32 s58, s75, 10
  s_lshl_b32 s59, s62, 7
  s_add_u32 s58, s58, s59
  s_lshl_b32 s59, s74, 6
  s_add_u32 s58, s58, s59
  v_and_b32 v32, 31, v1
  v_lshlrev_b32 v32, 10, v32
  v_lshrrev_b32 v33, 5, v1
  v_lshl_add_u32 v32, v33, 4, v32
  s_lshl_b32 s68, s67, 14
  s_add_u32 s54, s68, 66560
  v_add_u32 v34, s54, v2
  s_lshl_b32 s54, s67, 12
  s_add_u32 s54, s54, 66560
  v_add_u32 v35, s54, v2
  s_mov_b32 s44, s8
  s_mov_b32 s45, s9
  s_mov_b32 s46, 524288
  s_mov_b32 s47, 0x20000
  s_lshl_b32 s56, s67, 14
  s_add_u32 s56, s56, 1024
  s_lshl_b32 s57, s67, 17
  s_waitcnt vmcnt(0)
  v_sub_f32 v41, 1.0, v39
  v_cvt_pk_bf16_f32 v41, v41, v41
  v_and_b32 v41, 0xffff0000, v41
  v_lshlrev_b32 v8, 16, v42
  v_and_b32 v9, 0xffff0000, v42
  v_lshlrev_b32 v10, 16, v43
  v_and_b32 v11, 0xffff0000, v43
  v_lshlrev_b32 v12, 16, v44
  v_and_b32 v13, 0xffff0000, v44
  v_lshlrev_b32 v14, 16, v45
  v_and_b32 v15, 0xffff0000, v45
  v_lshlrev_b32 v16, 16, v46
  v_and_b32 v17, 0xffff0000, v46
  v_lshlrev_b32 v18, 16, v47
  v_and_b32 v19, 0xffff0000, v47
  v_lshlrev_b32 v20, 16, v48
  v_and_b32 v21, 0xffff0000, v48
  v_lshlrev_b32 v22, 16, v49
  v_and_b32 v23, 0xffff0000, v49
  v_mov_b32 v36, 24
  s_mov_b32 s50, 0x400000
L_spin14:
  ds_read_b32 v37, v36
  s_waitcnt lgkmcnt(0)
  v_readfirstlane_b32 s51, v37
  s_sub_u32 s50, s50, 1
  s_cmp_ge_u32 s51, 4
  s_cbranch_scc1 L_spind15
  s_cmp_eq_u32 s50, 0
  s_cbranch_scc1 L_spind15
  s_sleep 1
  s_branch L_spin14
L_spind15:
  ds_write_b128 v34, v[104:107] offset:0
  ds_write_b128 v34, v[108:111] offset:1024
  ds_write_b128 v34, v[112:115] offset:2048
  ds_write_b128 v34, v[116:119] offset:3072
  ds_write_b128 v34, v[120:123] offset:4096
  ds_write_b128 v34, v[124:127] offset:5120
  ds_write_b128 v34, v[128:131] offset:6144
  ds_write_b128 v34, v[132:135] offset:7168
  ds_write_b128 v34, v[136:139] offset:8192
  ds_write_b128 v34, v[140:143] offset:9216
  ds_write_b128 v34, v[144:147] offset:10240
  ds_write_b128 v34, v[148:151] offset:11264
  ds_write_b128 v34, v[152:155] offset:12288
  ds_write_b128 v34, v[156:159] offset:13312
  ds_write_b128 v34, v[160:163] offset:14336
  ds_write_b128 v34, v[164:167] offset:15360
  s_waitcnt lgkmcnt(0)
  v_mov_b32 v36, 28
  v_mov_b32 v37, 1
  s_mov_b64 exec, 1
  ds_add_u32 v36, v37
  s_mov_b64 exec, -1
  s_add_u32 m0, s56, 0
  s_add_u32 s69, s57, 0
  buffer_load_dwordx4 v3, s[44:47], s69 offen lds
  s_add_u32 m0, s56, 1024
  s_add_u32 s69, s57, 8192
  buffer_load_dwordx4 v3, s[44:47], s69 offen lds
  s_add_u32 m0, s56, 2048
  s_add_u32 s69, s57, 16384
  buffer_load_dwordx4 v3, s[44:47], s69 offen lds
  s_add_u32 m0, s56, 3072
  s_add_u32 s69, s57, 24576
  buffer_load_dwordx4 v3, s[44:47], s69 offen lds
  s_add_u32 m0, s56, 4096
  s_add_u32 s69, s57, 32768
  buffer_load_dwordx4 v3, s[44:47], s69 offen lds
  s_add_u32 m0, s56, 5120
  s_add_u32 s69, s57, 40960
  buffer_load_dwordx4 v3, s[44:47], s69 offen lds
  s_add_u32 m0, s56, 6144
  s_add_u32 s69, s57, 49152
  buffer_load_dwordx4 v3, s[44:47], s69 offen lds
  s_add_u32 m0, s56, 7168
  s_add_u32 s69, s57, 57344
  buffer_load_dwordx4 v3, s[44:47], s69 offen lds
  s_add_u32 m0, s56, 8192
  s_add_u32 s69, s57, 65536
  buffer_load_dwordx4 v3, s[44:47], s69 offen lds
  s_add_u32 m0, s56, 9216
  s_add_u32 s69, s57, 73728
  buffer_load_dwordx4 v3, s[44:47], s69 offen lds
  s_add_u32 m0, s56, 10240
  s_add_u32 s69, s57, 81920
  buffer_load_dwordx4 v3, s[44:47], s69 offen lds
  s_add_u32 m0, s56, 11264
  s_add_u32 s69, s57, 90112
  buffer_load_dwordx4 v3, s[44:47], s69 offen lds
  s_add_u32 m0, s56, 12288
  s_add_u32 s69, s57, 98304
  buffer_load_dwordx4 v3, s[44:47], s69 offen lds
  s_add_u32 m0, s56, 13312
  s_add_u32 s69, s57, 106496
  buffer_load_dwordx4 v3, s[44:47], s69 offen lds
  s_add_u32 m0, s56, 14336
  s_add_u32 s69, s57, 114688
  buffer_load_dwordx4 v3, s[44:47], s69 offen lds
  s_add_u32 m0, s56, 15360
  s_add_u32 s69, s57, 122880
  buffer_load_dwordx4 v3, s[44:47], s69 offen lds
  v_mov_b32 v36, 28
  s_mov_b32 s50, 0x400000
L_spin16:
  ds_read_b32 v37, v36
  s_waitcnt lgkmcnt(0)
  v_readfirstlane_b32 s51, v37
  s_sub_u32 s50, s50, 1
  s_cmp_ge_u32 s51, 4
  s_cbranch_scc1 L_spind17
  s_cmp_eq_u32 s50, 0
  s_cbranch_scc1 L_spind17
  s_sleep 1
  s_branch L_spin16
L_spind17:
  ds_read_b128 v[104:107], v35 offset:0
  ds_read_b128 v[108:111], v35 offset:1024
  ds_read_b128 v[112:115], v35 offset:2048
  ds_read_b128 v[116:119], v35 offset:3072
  ds_read_b128 v[120:123], v35 offset:16384
  ds_read_b128 v[124:127], v35 offset:17408
  ds_read_b128 v[128:131], v35 offset:18432
  ds_read_b128 v[132:135], v35 offset:19456
  ds_read_b128 v[136:139], v35 offset:32768
  ds_read_b128 v[140:143], v35 offset:33792
  ds_read_b128 v[144:147], v35 offset:34816
  ds_read_b128 v[148:151], v35 offset:35840
  ds_read_b128 v[152:155], v35 offset:49152
  ds_read_b128 v[156:159], v35 offset:50176
  ds_read_b128 v[160:163], v35 offset:51200
  ds_read_b128 v[164:167], v35 offset:52224
  s_waitcnt lgkmcnt(0)
  v_add_f32 v104, v104, v120
  v_add_f32 v136, v136, v152
  v_add_f32 v105, v105, v121
  v_add_f32 v137, v137, v153
  v_add_f32 v106, v106, v122
  v_add_f32 v138, v138, v154
  v_add_f32 v107, v107, v123
  v_add_f32 v139, v139, v155
  v_add_f32 v108, v108, v124
  v_add_f32 v140, v140, v156
  v_add_f32 v109, v109, v125
  v_add_f32 v141, v141, v157
  v_add_f32 v110, v110, v126
  v_add_f32 v142, v142, v158
  v_add_f32 v111, v111, v127
  v_add_f32 v143, v143, v159
  v_add_f32 v112, v112, v128
  v_add_f32 v144, v144, v160
  v_add_f32 v113, v113, v129
  v_add_f32 v145, v145, v161
  v_add_f32 v114, v114, v130
  v_add_f32 v146, v146, v162
  v_add_f32 v115, v115, v131
  v_add_f32 v147, v147, v163
  v_add_f32 v116, v116, v132
  v_add_f32 v148, v148, v164
  v_add_f32 v117, v117, v133
  v_add_f32 v149, v149, v165
  v_add_f32 v118, v118, v134
  v_add_f32 v150, v150, v166
  v_add_f32 v119, v119, v135
  v_add_f32 v151, v151, v167
  v_add_f32 v104, v104, v136
  v_add_f32 v105, v105, v137
  v_add_f32 v106, v106, v138
  v_add_f32 v107, v107, v139
  v_add_f32 v108, v108, v140
  v_add_f32 v109, v109, v141
  v_add_f32 v110, v110, v142
  v_add_f32 v111, v111, v143
  v_add_f32 v112, v112, v144
  v_add_f32 v113, v113, v145
  v_add_f32 v114, v114, v146
  v_add_f32 v115, v115, v147
  v_add_f32 v116, v116, v148
  v_add_f32 v117, v117, v149
  v_add_f32 v118, v118, v150
  v_add_f32 v119, v119, v151
  v_add_f32 v8, v104, v8
  v_add_f32 v9, v105, v9
  v_add_f32 v10, v106, v10
  v_add_f32 v11, v107, v11
  v_add_f32 v12, v108, v12
  v_add_f32 v13, v109, v13
  v_add_f32 v14, v110, v14
  v_add_f32 v15, v111, v15
  v_add_f32 v16, v112, v16
  v_add_f32 v17, v113, v17
  v_add_f32 v18, v114, v18
  v_add_f32 v19, v115, v19
  v_add_f32 v20, v116, v20
  v_add_f32 v21, v117, v21
  v_add_f32 v22, v118, v22
  v_add_f32 v23, v119, v23
  v_mul_f32 v8, v8, v41
  v_mul_f32 v9, v9, v41
  v_mul_f32 v10, v10, v41
  v_mul_f32 v11, v11, v41
  v_mul_f32 v12, v12, v41
  v_mul_f32 v13, v13, v41
  v_mul_f32 v14, v14, v41
  v_mul_f32 v15, v15, v41
  v_mul_f32 v16, v16, v41
  v_mul_f32 v17, v17, v41
  v_mul_f32 v18, v18, v41
  v_mul_f32 v19, v19, v41
  v_mul_f32 v20, v20, v41
  v_mul_f32 v21, v21, v41
  v_mul_f32 v22, v22, v41
  v_mul_f32 v23, v23, v41
  s_add_u32 s36, s26, 14684160
  s_addc_u32 s37, s27, 0
  s_mov_b32 s38, 2097152
  s_mov_b32 s39, 0x20000
  s_mov_b32 s32, s22
  s_mov_b32 s33, s23
  s_mov_b32 s34, 2097152
  s_mov_b32 s35, 0x20000
  s_cmp_lg_u32 s67, 0
  s_cbranch_scc1 L_f4
  s_lshl_b32 s54, s61, 8
  s_add_u32 s54, s54, 8192
  v_lshlrev_b32 v121, 2, v1
  s_mov_b32 s50, 0x40000
L_poll18:
  buffer_load_dword v122, v121, s[40:43], s54 offen sc1
  s_waitcnt vmcnt(0)
  v_cmp_ne_u32 vcc, s60, v122
  s_cbranch_vccz L_polld19
  s_sub_u32 s50, s50, 1
  s_cmp_eq_u32 s50, 0
  s_cbranch_scc1 L_polld19
  s_sleep 2
  s_branch L_poll18
L_polld19:
  s_mov_b64 exec, -1
L_f4:
  s_lshl_b32 s54, s61, 16
  s_lshl_b32 s55, s67, 11
  s_add_u32 s54, s54, s55
  s_add_u32 s55, s55, 66560
  s_waitcnt vmcnt(0)
  s_barrier
  s_add_u32 m0, s55, 0
  s_add_u32 s56, s54, 0
  buffer_load_dwordx4 v2, s[36:39], s56 offen sc1 lds
  s_add_u32 m0, s55, 32768
  s_add_u32 s56, s54, 32768
  buffer_load_dwordx4 v2, s[36:39], s56 offen sc1 lds
  s_add_u32 m0, s55, 1024
  s_add_u32 s56, s54, 1024
  buffer_load_dwordx4 v2, s[36:39], s56 offen sc1 lds
  s_add_u32 m0, s55, 33792
  s_add_u32 s56, s54, 33792
  buffer_load_dwordx4 v2, s[36:39], s56 offen sc1 lds
  ds_read_b64_tr_b16 v[40:41], v4 offset:0
  ds_read_b64_tr_b16 v[42:43], v4 offset:1024
  ds_read_b64_tr_b16 v[48:49], v4 offset:2048
  ds_read_b64_tr_b16 v[50:51], v4 offset:3072
  ds_read_b64_tr_b16 v[56:57], v4 offset:4096
  ds_read_b64_tr_b16 v[58:59], v4 offset:5120
  ds_read_b64_tr_b16 v[64:65], v4 offset:6144
  ds_read_b64_tr_b16 v[66:67], v4 offset:7168
  ds_read_b64_tr_b16 v[72:73], v4 offset:8192
  ds_read_b64_tr_b16 v[74:75], v4 offset:9216
  ds_read_b64_tr_b16 v[80:81], v4 offset:10240
  ds_read_b64_tr_b16 v[82:83], v4 offset:11264
  ds_read_b64_tr_b16 v[88:89], v4 offset:12288
  ds_read_b64_tr_b16 v[90:91], v4 offset:13312
  ds_read_b64_tr_b16 v[96:97], v4 offset:14336
  ds_read_b64_tr_b16 v[98:99], v4 offset:15360
  s_waitcnt lgkmcnt(8)
  s_add_u32 m0, s55, 8192
  s_add_u32 s56, s54, 8192
  buffer_load_dwordx4 v2, s[36:39], s56 offen sc1 lds
  s_add_u32 m0, s55, 40960
  s_add_u32 s56, s54, 40960
  buffer_load_dwordx4 v2, s[36:39], s56 offen sc1 lds
  s_add_u32 m0, s55, 9216
  s_add_u32 s56, s54, 9216
  buffer_load_dwordx4 v2, s[36:39], s56 offen sc1 lds
  s_add_u32 m0, s55, 41984
  s_add_u32 s56, s54, 41984
  buffer_load_dwordx4 v2, s[36:39], s56 offen sc1 lds
  s_add_u32 m0, s55, 16384
  s_add_u32 s56, s54, 16384
  buffer_load_dwordx4 v2, s[36:39], s56 offen sc1 lds
  s_add_u32 m0, s55, 49152
  s_add_u32 s56, s54, 49152
  buffer_load_dwordx4 v2, s[36:39], s56 offen sc1 lds
  s_add_u32 m0, s55, 17408
  s_add_u32 s56, s54, 17408
  buffer_load_dwordx4 v2, s[36:39], s56 offen sc1 lds
  s_add_u32 m0, s55, 50176
  s_add_u32 s56, s54, 50176
  buffer_load_dwordx4 v2, s[36:39], s56 offen sc1 lds
  s_add_u32 m0, s55, 24576
  s_add_u32 s56, s54, 24576
  buffer_load_dwordx4 v2, s[36:39], s56 offen sc1 lds
  s_add_u32 m0, s55, 57344
  s_add_u32 s56, s54, 57344
  buffer_load_dwordx4 v2, s[36:39], s56 offen sc1 lds
  s_add_u32 m0, s55, 25600
  s_add_u32 s56, s54, 25600
  buffer_load_dwordx4 v2, s[36:39], s56 offen sc1 lds
  s_add_u32 m0, s55, 58368
  s_add_u32 s56, s54, 58368
  buffer_load_dwordx4 v2, s[36:39], s56 offen sc1 lds
  s_waitcnt vmcnt(12) lgkmcnt(0)
  s_barrier
  ds_read_b128 v[44:47], v5 offset:0
  ds_read_b128 v[52:55], v5 offset:1024
  ds_read_b128 v[60:63], v5 offset:2048
  ds_read_b128 v[68:71], v5 offset:3072
  ds_read_b128 v[76:79], v5 offset:4096
  ds_read_b128 v[84:87], v5 offset:5120
  ds_read_b128 v[92:95], v5 offset:6144
  ds_read_b128 v[100:103], v5 offset:7168
  s_waitcnt lgkmcnt(7)
  v_mfma_f32_32x32x16_bf16 v[104:119], v[40:43], v[44:47], 0
  ds_read_b64_tr_b16 v[40:41], v4 offset:16384
  ds_read_b64_tr_b16 v[42:43], v4 offset:17408
  s_waitcnt lgkmcnt(8)
  v_mfma_f32_32x32x16_bf16 v[104:119], v[48:51], v[52:55], v[104:119]
  ds_read_b64_tr_b16 v[48:49], v4 offset:18432
  ds_read_b64_tr_b16 v[50:51], v4 offset:19456
  s_waitcnt lgkmcnt(9)
  v_mfma_f32_32x32x16_bf16 v[104:119], v[56:59], v[60:63], v[104:119]
  ds_read_b64_tr_b16 v[56:57], v4 offset:20480
  ds_read_b64_tr_b16 v[58:59], v4 offset:21504
  s_waitcnt lgkmcnt(10)
  v_mfma_f32_32x32x16_bf16 v[104:119], v[64:67], v[68:71], v[104:119]
  ds_read_b64_tr_b16 v[64:65], v4 offset:22528
  ds_read_b64_tr_b16 v[66:67], v4 offset:23552
  s_waitcnt lgkmcnt(11)
  v_mfma_f32_32x32x16_bf16 v[104:119], v[72:75], v[76:79], v[104:119]
  ds_read_b64_tr_b16 v[72:73], v4 offset:24576
  ds_read_b64_tr_b16 v[74:75], v4 offset:25600
  s_waitcnt lgkmcnt(12)
  v_mfma_f32_32x32x16_bf16 v[104:119], v[80:83], v[84:87], v[104:119]
  ds_read_b64_tr_b16 v[80:81], v4 offset:26624
  ds_read_b64_tr_b16 v[82:83], v4 offset:27648
  s_waitcnt lgkmcnt(13)
  v_mfma_f32_32x32x16_bf16 v[104:119], v[88:91], v[92:95], v[104:119]
  ds_read_b64_tr_b16 v[88:89], v4 offset:28672
  ds_read_b64_tr_b16 v[90:91], v4 offset:29696
  s_waitcnt lgkmcnt(14)
  v_mfma_f32_32x32x16_bf16 v[104:119], v[96:99], v[100:103], v[104:119]
  ds_read_b64_tr_b16 v[96:97], v4 offset:30720
  ds_read_b64_tr_b16 v[98:99], v4 offset:31744
  s_waitcnt vmcnt(8) lgkmcnt(0)
  s_barrier
  ds_read_b128 v[44:47], v5 offset:8192
  ds_read_b128 v[52:55], v5 offset:9216
  ds_read_b128 v[60:63], v5 offset:10240
  ds_read_b128 v[68:71], v5 offset:11264
  ds_read_b128 v[76:79], v5 offset:12288
  ds_read_b128 v[84:87], v5 offset:13312
  ds_read_b128 v[92:95], v5 offset:14336
  ds_read_b128 v[100:103], v5 offset:15360
  s_waitcnt lgkmcnt(7)
  v_mfma_f32_32x32x16_bf16 v[104:119], v[40:43], v[44:47], v[104:119]
  ds_read_b64_tr_b16 v[40:41], v4 offset:32768
  ds_read_b64_tr_b16 v[42:43], v4 offset:33792
  s_waitcnt lgkmcnt(8)
  v_mfma_f32_32x32x16_bf16 v[104:119], v[48:51], v[52:55], v[104:119]
  ds_read_b64_tr_b16 v[48:49], v4 offset:34816
  ds_read_b64_tr_b16 v[50:51], v4 offset:35840
  s_waitcnt lgkmcnt(9)
  v_mfma_f32_32x32x16_bf16 v[104:119], v[56:59], v[60:63], v[104:119]
  ds_read_b64_tr_b16 v[56:57], v4 offset:36864
  ds_read_b64_tr_b16 v[58:59], v4 offset:37888
  s_waitcnt lgkmcnt(10)
  v_mfma_f32_32x32x16_bf16 v[104:119], v[64:67], v[68:71], v[104:119]
  ds_read_b64_tr_b16 v[64:65], v4 offset:38912
  ds_read_b64_tr_b16 v[66:67], v4 offset:39936
  s_waitcnt lgkmcnt(11)
  v_mfma_f32_32x32x16_bf16 v[104:119], v[72:75], v[76:79], v[104:119]
  ds_read_b64_tr_b16 v[72:73], v4 offset:40960
  ds_read_b64_tr_b16 v[74:75], v4 offset:41984
  s_waitcnt lgkmcnt(12)
  v_mfma_f32_32x32x16_bf16 v[104:119], v[80:83], v[84:87], v[104:119]
  ds_read_b64_tr_b16 v[80:81], v4 offset:43008
  ds_read_b64_tr_b16 v[82:83], v4 offset:44032
  s_waitcnt lgkmcnt(13)
  v_mfma_f32_32x32x16_bf16 v[104:119], v[88:91], v[92:95], v[104:119]
  ds_read_b64_tr_b16 v[88:89], v4 offset:45056
  ds_read_b64_tr_b16 v[90:91], v4 offset:46080
  s_waitcnt lgkmcnt(14)
  v_mfma_f32_32x32x16_bf16 v[104:119], v[96:99], v[100:103], v[104:119]
  ds_read_b64_tr_b16 v[96:97], v4 offset:47104
  ds_read_b64_tr_b16 v[98:99], v4 offset:48128
  s_waitcnt vmcnt(4) lgkmcnt(0)
  s_barrier
  ds_read_b128 v[44:47], v5 offset:16384
  ds_read_b128 v[52:55], v5 offset:17408
  ds_read_b128 v[60:63], v5 offset:18432
  ds_read_b128 v[68:71], v5 offset:19456
  ds_read_b128 v[76:79], v5 offset:20480
  ds_read_b128 v[84:87], v5 offset:21504
  ds_read_b128 v[92:95], v5 offset:22528
  ds_read_b128 v[100:103], v5 offset:23552
  s_waitcnt lgkmcnt(7)
  v_mfma_f32_32x32x16_bf16 v[104:119], v[40:43], v[44:47], v[104:119]
  ds_read_b64_tr_b16 v[40:41], v4 offset:49152
  ds_read_b64_tr_b16 v[42:43], v4 offset:50176
  s_waitcnt lgkmcnt(8)
  v_mfma_f32_32x32x16_bf16 v[104:119], v[48:51], v[52:55], v[104:119]
  ds_read_b64_tr_b16 v[48:49], v4 offset:51200
  ds_read_b64_tr_b16 v[50:51], v4 offset:52224
  s_waitcnt lgkmcnt(9)
  v_mfma_f32_32x32x16_bf16 v[104:119], v[56:59], v[60:63], v[104:119]
  ds_read_b64_tr_b16 v[56:57], v4 offset:53248
  ds_read_b64_tr_b16 v[58:59], v4 offset:54272
  s_waitcnt lgkmcnt(10)
  v_mfma_f32_32x32x16_bf16 v[104:119], v[64:67], v[68:71], v[104:119]
  ds_read_b64_tr_b16 v[64:65], v4 offset:55296
  ds_read_b64_tr_b16 v[66:67], v4 offset:56320
  s_waitcnt lgkmcnt(11)
  v_mfma_f32_32x32x16_bf16 v[104:119], v[72:75], v[76:79], v[104:119]
  ds_read_b64_tr_b16 v[72:73], v4 offset:57344
  ds_read_b64_tr_b16 v[74:75], v4 offset:58368
  s_waitcnt lgkmcnt(12)
  v_mfma_f32_32x32x16_bf16 v[104:119], v[80:83], v[84:87], v[104:119]
  ds_read_b64_tr_b16 v[80:81], v4 offset:59392
  ds_read_b64_tr_b16 v[82:83], v4 offset:60416
  s_waitcnt lgkmcnt(13)
  v_mfma_f32_32x32x16_bf16 v[104:119], v[88:91], v[92:95], v[104:119]
  ds_read_b64_tr_b16 v[88:89], v4 offset:61440
  ds_read_b64_tr_b16 v[90:91], v4 offset:62464
  s_waitcnt lgkmcnt(14)
  v_mfma_f32_32x32x16_bf16 v[104:119], v[96:99], v[100:103], v[104:119]
  ds_read_b64_tr_b16 v[96:97], v4 offset:63488
  ds_read_b64_tr_b16 v[98:99], v4 offset:64512
  s_waitcnt vmcnt(0) lgkmcnt(0)
  s_barrier
  ds_read_b128 v[44:47], v5 offset:24576
  ds_read_b128 v[52:55], v5 offset:25600
  ds_read_b128 v[60:63], v5 offset:26624
  ds_read_b128 v[68:71], v5 offset:27648
  ds_read_b128 v[76:79], v5 offset:28672
  ds_read_b128 v[84:87], v5 offset:29696
  ds_read_b128 v[92:95], v5 offset:30720
  ds_read_b128 v[100:103], v5 offset:31744
  s_waitcnt lgkmcnt(7)
  v_mfma_f32_32x32x16_bf16 v[104:119], v[40:43], v[44:47], v[104:119]
  s_waitcnt lgkmcnt(6)
  v_mfma_f32_32x32x16_bf16 v[104:119], v[48:51], v[52:55], v[104:119]
  s_waitcnt lgkmcnt(5)
  v_mfma_f32_32x32x16_bf16 v[104:119], v[56:59], v[60:63], v[104:119]
  s_waitcnt lgkmcnt(4)
  v_mfma_f32_32x32x16_bf16 v[104:119], v[64:67], v[68:71], v[104:119]
  s_waitcnt lgkmcnt(3)
  v_mfma_f32_32x32x16_bf16 v[104:119], v[72:75], v[76:79], v[104:119]
  s_waitcnt lgkmcnt(2)
  v_mfma_f32_32x32x16_bf16 v[104:119], v[80:83], v[84:87], v[104:119]
  s_waitcnt lgkmcnt(1)
  v_mfma_f32_32x32x16_bf16 v[104:119], v[88:91], v[92:95], v[104:119]
  s_waitcnt lgkmcnt(0)
  v_mfma_f32_32x32x16_bf16 v[104:119], v[96:99], v[100:103], v[104:119]
  s_nop 15
  v_fma_f32 v104, v104, v39, v8
  v_fma_f32 v105, v105, v39, v9
  v_fma_f32 v106, v106, v39, v10
  v_fma_f32 v107, v107, v39, v11
  v_fma_f32 v108, v108, v39, v12
  v_fma_f32 v109, v109, v39, v13
  v_fma_f32 v110, v110, v39, v14
  v_fma_f32 v111, v111, v39, v15
  v_fma_f32 v112, v112, v39, v16
  v_fma_f32 v113, v113, v39, v17
  v_fma_f32 v114, v114, v39, v18
  v_fma_f32 v115, v115, v39, v19
  v_fma_f32 v116, v116, v39, v20
  v_fma_f32 v117, v117, v39, v21
  v_fma_f32 v118, v118, v39, v22
  v_fma_f32 v119, v119, v39, v23
  v_cvt_pk_bf16_f32 v104, v104, v105
  v_cvt_pk_bf16_f32 v105, v106, v107
  v_cvt_pk_bf16_f32 v106, v108, v109
  v_cvt_pk_bf16_f32 v107, v110, v111
  v_cvt_pk_bf16_f32 v108, v112, v113
  v_cvt_pk_bf16_f32 v109, v114, v115
  v_cvt_pk_bf16_f32 v110, v116, v117
  v_cvt_pk_bf16_f32 v111, v118, v119
  s_nop 1
  v_permlane32_swap_b32 v104, v106
  v_permlane32_swap_b32 v105, v107
  v_permlane32_swap_b32 v108, v110
  v_permlane32_swap_b32 v109, v111
  buffer_store_dwordx4 v[104:107], v32, s[32:35], s58 offen
  buffer_store_dwordx4 v[108:111], v32, s[32:35], s58 offen offset:32
  s_endpgm
L_attn:
  s_and_b32 s63, s3, 3
  s_lshr_b32 s64, s3, 2
  v_lshlrev_b32 v4, 4, v1
  v_lshrrev_b32 v104, 5, v1
  v_and_b32 v105, 15, v1
  v_lshlrev_b32 v105, 4, v105
  v_lshl_add_u32 v109, v104, 8, v105
  v_add_u32 v109, 66560, v109
  v_add_u32 v107, 1024, v4
  s_lshl_b32 s54, s64, 12
  v_add_u32 v2, s54, v4
  v_add_u32 v3, s54, v109
  s_lshl_b32 s54, s63, 2
  s_add_u32 s54, s54, 160
  v_mov_b32 v110, s54
  v_mov_b32 v111, 1
  s_mov_b32 s74, 0x0000ffff
  s_mov_b32 s75, 0x0000ffff
  s_mov_b32 s77, 0
  s_lshl_b32 s66, s62, 3
  s_lshl_b32 s54, s63, 1
  s_add_u32 s66, s66, s54
  s_lshl_b32 s54, s63, 11
  s_add_u32 s54, s54, 132096
  v_add_u32 v106, s54, v4
  v_and_b32 v104, 31, v1
  v_cmp_eq_u32 vcc, 16, v104
  v_mov_b32 v105, 0x3f803f80
  s_nop 1
  v_cndmask_b32 v104, 0, v105, vcc
  v_mov_b32 v24, v104
  v_mov_b32 v25, v104
  v_mov_b32 v26, v104
  v_mov_b32 v27, v104
  v_mov_b32 v28, v104
  v_mov_b32 v29, v104
  v_mov_b32 v30, v104
  v_mov_b32 v31, v104
  v_mov_b32 v32, v104
  v_mov_b32 v33, v104
  v_mov_b32 v34, v104
  v_mov_b32 v35, v104
  v_mov_b32 v36, v104
  v_mov_b32 v37, v104
  v_mov_b32 v38, v104
  v_mov_b32 v39, v104
  s_lshl_b32 s54, s63, 2
  s_add_u32 s55, s54, 64
  s_add_u32 s76, s54, 96
  v_mov_b32 v146, s55
  v_mov_b32 v147, s76
  s_mul_i32 s54, s63, 4608
  s_add_u32 s54, s54, 132096
  v_add_u32 v144, s54, v4
  v_lshlrev_b32 v145, 2, v1
  v_add_u32 v145, s54, v145
  v_mov_b32 v148, 128
  ds_read_b32 v148, v148
  s_waitcnt lgkmcnt(0)
  v_readfirstlane_b32 s60, v148
  v_mov_b32 v72, 0
  v_mov_b32 v88, 0
  v_mov_b32 v73, 0
  v_mov_b32 v89, 0
  v_mov_b32 v74, 0
  v_mov_b32 v90, 0
  v_mov_b32 v75, 0
  v_mov_b32 v91, 0
  v_mov_b32 v76, 0
  v_mov_b32 v92, 0
  v_mov_b32 v77, 0
  v_mov_b32 v93, 0
  v_mov_b32 v78, 0
  v_mov_b32 v94, 0
  v_mov_b32 v79, 0
  v_mov_b32 v95, 0
  v_mov_b32 v80, 0
  v_mov_b32 v96, 0
  v_mov_b32 v81, 0
  v_mov_b32 v97, 0
  v_mov_b32 v82, 0
  v_mov_b32 v98, 0
  v_mov_b32 v83, 0
  v_mov_b32 v99, 0
  v_mov_b32 v84, 0
  v_mov_b32 v100, 0
  v_mov_b32 v85, 0
  v_mov_b32 v101, 0
  v_mov_b32 v86, 0
  v_mov_b32 v102, 0
  v_mov_b32 v87, 0
  v_mov_b32 v103, 0
  v_mov_b32 v104, 0
  s_mov_b32 s50, 0x400000
L_spin20:
  ds_read_b32 v105, v104
  s_waitcnt lgkmcnt(0)
  v_readfirstlane_b32 s51, v105
  s_sub_u32 s50, s50, 1
  s_cmp_ge_u32 s51, 4
  s_cbranch_scc1 L_spind21
  s_cmp_eq_u32 s50, 0
  s_cbranch_scc1 L_spind21
  s_sleep 0
  s_branch L_spin20
L_spind21:
  ds_read_b128 v[8:11], v106
  ds_read_b128 v[12:15], v106 offset:1024
  s_lshl_b32 s71, s64, 12
  s_mov_b32 s73, 0
.p2align 6
L_aloop:
  v_add_u32 v2, s71, v107
  v_add_u32 v3, s71, v109
  ds_read_b128 v[16:19], v2 offset:0
  s_mov_b64 exec, s[74:75]
  ds_read_b128 v[24:27], v3 offset:0
  ds_read_b128 v[28:31], v3 offset:512
  s_mov_b64 exec, -1
  ds_read_b128 v[20:23], v2 offset:1024
  s_waitcnt lgkmcnt(3)
  v_mfma_f32_32x32x16_bf16 v[40:55], v[16:19], v[8:11], 0
  s_nop 7
  s_nop 3
  v_exp_f32 v40, v40
  v_exp_f32 v41, v41
  s_mov_b64 exec, s[74:75]
  ds_read_b128 v[32:35], v3 offset:1024
  ds_read_b128 v[36:39], v3 offset:1536
  s_mov_b64 exec, -1
  v_exp_f32 v42, v42
  v_exp_f32 v43, v43
  v_cvt_pk_bf16_f32 v40, v40, v41
  v_exp_f32 v44, v44
  v_exp_f32 v45, v45
  v_cvt_pk_bf16_f32 v41, v42, v43
  v_mfma_f32_32x32x16_bf16 v[56:71], v[16:19], v[12:15], 0
  ds_read_b128 v[16:19], v2 offset:2048
  v_exp_f32 v46, v46
  v_exp_f32 v47, v47
  v_cvt_pk_bf16_f32 v42, v44, v45
  v_exp_f32 v48, v48
  v_exp_f32 v49, v49
  v_cvt_pk_bf16_f32 v43, v46, v47
  v_exp_f32 v50, v50
  v_exp_f32 v51, v51
  s_waitcnt lgkmcnt(4)
  v_mfma_f32_32x32x16_bf16 v[72:87], v[24:27], v[40:43], v[72:87]
  v_cvt_pk_bf16_f32 v44, v48, v49
  v_exp_f32 v52, v52
  v_exp_f32 v53, v53
  v_cvt_pk_bf16_f32 v45, v50, v51
  v_exp_f32 v54, v54
  v_exp_f32 v55, v55
  v_cvt_pk_bf16_f32 v46, v52, v53
  v_cvt_pk_bf16_f32 v47, v54, v55
  v_exp_f32 v56, v56
  v_exp_f32 v57, v57
  v_mfma_f32_32x32x16_bf16 v[72:87], v[28:31], v[44:47], v[72:87]
  v_exp_f32 v58, v58
  v_exp_f32 v59, v59
  v_cvt_pk_bf16_f32 v56, v56, v57
  v_exp_f32 v60, v60
  v_exp_f32 v61, v61
  v_cvt_pk_bf16_f32 v57, v58, v59
  s_waitcnt lgkmcnt(3)
  v_mfma_f32_32x32x16_bf16 v[40:55], v[20:23], v[8:11], 0
  v_exp_f32 v62, v62
  v_exp_f32 v63, v63
  v_cvt_pk_bf16_f32 v58, v60, v61
  v_exp_f32 v64, v64
  v_exp_f32 v65, v65
  v_cvt_pk_bf16_f32 v59, v62, v63
  v_exp_f32 v66, v66
  v_exp_f32 v67, v67
  v_mfma_f32_32x32x16_bf16 v[88:103], v[24:27], v[56:59], v[88:103]
  v_cvt_pk_bf16_f32 v60, v64, v65
  v_exp_f32 v68, v68
  v_exp_f32 v69, v69
  v_cvt_pk_bf16_f32 v61, v66, v67
  v_exp_f32 v70, v70
  v_exp_f32 v71, v71
  v_cvt_pk_bf16_f32 v62, v68, v69
  v_cvt_pk_bf16_f32 v63, v70, v71
  v_exp_f32 v40, v40
  v_exp_f32 v41, v41
  v_mfma_f32_32x32x16_bf16 v[88:103], v[28:31], v[60:63], v[88:103]
  s_mov_b64 exec, s[74:75]
  ds_read_b128 v[24:27], v3 offset:2048
  ds_read_b128 v[28:31], v3 offset:2560
  s_mov_b64 exec, -1
  v_exp_f32 v42, v42
  v_exp_f32 v43, v43
  v_cvt_pk_bf16_f32 v40, v40, v41
  v_exp_f32 v44, v44
  v_exp_f32 v45, v45
  v_cvt_pk_bf16_f32 v41, v42, v43
  v_mfma_f32_32x32x16_bf16 v[56:71], v[20:23], v[12:15], 0
  ds_read_b128 v[20:23], v2 offset:3072
  v_exp_f32 v46, v46
  v_exp_f32 v47, v47
  v_cvt_pk_bf16_f32 v42, v44, v45
  v_exp_f32 v48, v48
  v_exp_f32 v49, v49
  v_cvt_pk_bf16_f32 v43, v46, v47
  v_exp_f32 v50, v50
  v_exp_f32 v51, v51
  s_waitcnt lgkmcnt(4)
  v_mfma_f32_32x32x16_bf16 v[72:87], v[32:35], v[40:43], v[72:87]
  v_cvt_pk_bf16_f32 v44, v48, v49
  v_exp_f32 v52, v52
  v_exp_f32 v53, v53
  v_cvt_pk_bf16_f32 v45, v50, v51
  v_exp_f32 v54, v54
  v_exp_f32 v55, v55
  v_cvt_pk_bf16_f32 v46, v52, v53
  v_cvt_pk_bf16_f32 v47, v54, v55
  v_exp_f32 v56, v56
  v_exp_f32 v57, v57
  v_mfma_f32_32x32x16_bf16 v[72:87], v[36:39], v[44:47], v[72:87]
  v_exp_f32 v58, v58
  v_exp_f32 v59, v59
  v_cvt_pk_bf16_f32 v56, v56, v57
  v_exp_f32 v60, v60
  v_exp_f32 v61, v61
  v_cvt_pk_bf16_f32 v57, v58, v59
  s_waitcnt lgkmcnt(3)
  v_mfma_f32_32x32x16_bf16 v[40:55], v[16:19], v[8:11], 0
  v_exp_f32 v62, v62
  v_exp_f32 v63, v63
  v_cvt_pk_bf16_f32 v58, v60, v61
  v_exp_f32 v64, v64
  v_exp_f32 v65, v65
  v_cvt_pk_bf16_f32 v59, v62, v63
  v_exp_f32 v66, v66
  v_exp_f32 v67, v67
  v_mfma_f32_32x32x16_bf16 v[88:103], v[32:35], v[56:59], v[88:103]
  v_cvt_pk_bf16_f32 v60, v64, v65
  v_exp_f32 v68, v68
  v_exp_f32 v69, v69
  v_cvt_pk_bf16_f32 v61, v66, v67
  v_exp_f32 v70, v70
  v_exp_f32 v71, v71
  v_cvt_pk_bf16_f32 v62, v68, v69
  v_cvt_pk_bf16_f32 v63, v70, v71
  v_exp_f32 v40, v40
  v_exp_f32 v41, v41
  v_mfma_f32_32x32x16_bf16 v[88:103], v[36:39], v[60:63], v[88:103]
  s_mov_b64 exec, s[74:75]
  ds_read_b128 v[32:35], v3 offset:3072
  ds_read_b128 v[36:39], v3 offset:3584
  s_mov_b64 exec, -1
  v_exp_f32 v42, v42
  v_exp_f32 v43, v43
  v_cvt_pk_bf16_f32 v40, v40, v41
  v_exp_f32 v44, v44
  v_exp_f32 v45, v45
  v_cvt_pk_bf16_f32 v41, v42, v43
  v_mfma_f32_32x32x16_bf16 v[56:71], v[16:19], v[12:15], 0
  v_exp_f32 v46, v46
  v_exp_f32 v47, v47
  v_cvt_pk_bf16_f32 v42, v44, v45
  v_exp_f32 v48, v48
  v_exp_f32 v49, v49
  v_cvt_pk_bf16_f32 v43, v46, v47
  v_exp_f32 v50, v50
  v_exp_f32 v51, v51
  s_waitcnt lgkmcnt(3)
  v_mfma_f32_32x32x16_bf16 v[72:87], v[24:27], v[40:43], v[72:87]
  v_cvt_pk_bf16_f32 v44, v48, v49
  v_exp_f32 v52, v52
  v_exp_f32 v53, v53
  v_cvt_pk_bf16_f32 v45, v50, v51
  v_exp_f32 v54, v54
  v_exp_f32 v55, v55
  v_cvt_pk_bf16_f32 v46, v52, v53
  v_cvt_pk_bf16_f32 v47, v54, v55
  v_exp_f32 v56, v56
  v_exp_f32 v57, v57
  v_mfma_f32_32x32x16_bf16 v[72:87], v[28:31], v[44:47], v[72:87]
  v_exp_f32 v58, v58
  v_exp_f32 v59, v59
  v_cvt_pk_bf16_f32 v56, v56, v57
  v_exp_f32 v60, v60
  v_exp_f32 v61, v61
  v_cvt_pk_bf16_f32 v57, v58, v59
  s_waitcnt lgkmcnt(2)
  v_mfma_f32_32x32x16_bf16 v[40:55], v[20:23], v[8:11], 0
  v_exp_f32 v62, v62
  v_exp_f32 v63, v63
  v_cvt_pk_bf16_f32 v58, v60, v61
  v_exp_f32 v64, v64
  v_exp_f32 v65, v65
  v_cvt_pk_bf16_f32 v59, v62, v63
  v_exp_f32 v66, v66
  v_exp_f32 v67, v67
  v_mfma_f32_32x32x16_bf16 v[88:103], v[24:27], v[56:59], v[88:103]
  v_cvt_pk_bf16_f32 v60, v64, v65
  v_exp_f32 v68, v68
  v_exp_f32 v69, v69
  v_cvt_pk_bf16_f32 v61, v66, v67
  v_exp_f32 v70, v70
  v_exp_f32 v71, v71
  v_cvt_pk_bf16_f32 v62, v68, v69
  v_cvt_pk_bf16_f32 v63, v70, v71
  v_exp_f32 v40, v40
  v_exp_f32 v41, v41
  v_mfma_f32_32x32x16_bf16 v[88:103], v[28:31], v[60:63], v[88:103]
  v_exp_f32 v42, v42
  v_exp_f32 v43, v43
  v_cvt_pk_bf16_f32 v40, v40, v41
  v_exp_f32 v44, v44
  v_exp_f32 v45, v45
  v_cvt_pk_bf16_f32 v41, v42, v43
  v_mfma_f32_32x32x16_bf16 v[56:71], v[20:23], v[12:15], 0
  v_exp_f32 v46, v46
  v_exp_f32 v47, v47
  v_cvt_pk_bf16_f32 v42, v44, v45
  v_exp_f32 v48, v48
  v_exp_f32 v49, v49
  v_cvt_pk_bf16_f32 v43, v46, v47
  v_exp_f32 v50, v50
  v_exp_f32 v51, v51
  s_waitcnt lgkmcnt(0)
  v_mfma_f32_32x32x16_bf16 v[72:87], v[32:35], v[40:43], v[72:87]
  v_cvt_pk_bf16_f32 v44, v48, v49
  v_exp_f32 v52, v52
  v_exp_f32 v53, v53
  v_cvt_pk_bf16_f32 v45, v50, v51
  v_exp_f32 v54, v54
  v_exp_f32 v55, v55
  v_cvt_pk_bf16_f32 v46, v52, v53
  v_cvt_pk_bf16_f32 v47, v54, v55
  v_exp_f32 v56, v56
  v_exp_f32 v57, v57
  v_mfma_f32_32x32x16_bf16 v[72:87], v[36:39], v[44:47], v[72:87]
  s_mov_b64 exec, 1
  ds_add_rtn_u32 v5, v110, v111
  s_mov_b64 exec, -1
  v_exp_f32 v58, v58
  v_exp_f32 v59, v59
  v_cvt_pk_bf16_f32 v56, v56, v57
  v_exp_f32 v60, v60
  v_exp_f32 v61, v61
  v_cvt_pk_bf16_f32 v57, v58, v59
  v_exp_f32 v62, v62
  v_exp_f32 v63, v63
  v_cvt_pk_bf16_f32 v58, v60, v61
  v_exp_f32 v64, v64
  v_exp_f32 v65, v65
  v_cvt_pk_bf16_f32 v59, v62, v63
  v_exp_f32 v66, v66
  v_exp_f32 v67, v67
  v_mfma_f32_32x32x16_bf16 v[88:103], v[32:35], v[56:59], v[88:103]
  v_cvt_pk_bf16_f32 v60, v64, v65
  v_exp_f32 v68, v68
  v_exp_f32 v69, v69
  v_cvt_pk_bf16_f32 v61, v66, v67
  v_exp_f32 v70, v70
  v_exp_f32 v71, v71
  v_cvt_pk_bf16_f32 v62, v68, v69
  v_cvt_pk_bf16_f32 v63, v70, v71
  s_waitcnt lgkmcnt(0)
  v_readfirstlane_b32 s70, v5
  v_mfma_f32_32x32x16_bf16 v[88:103], v[36:39], v[60:63], v[88:103]
  s_add_u32 s70, s70, 2
  s_lshl_b32 s71, s70, 12
  s_cmp_ge_u32 s73, 2
  s_cbranch_scc1 L_aloop2
  s_cmp_eq_u32 s73, 1
  s_cbranch_scc1 L_aloop3
  s_mov_b32 s73, 1
  v_mov_b32 v104, 12
  v_mov_b32 v105, 1
  s_mov_b64 exec, 1
  ds_add_u32 v104, v105
  s_mov_b64 exec, -1
  s_cmp_ge_u32 s3, 4
  s_cbranch_scc1 L_aloop1
  s_add_u32 s55, s83, 0
  buffer_store_dwordx4 v[120:123], v4, s[32:35], s55 offen sc1
  s_add_u32 s55, s83, 65536
  buffer_store_dwordx4 v[124:127], v4, s[32:35], s55 offen sc1
  s_add_u32 s55, s83, 262144
  buffer_store_dwordx4 v[128:131], v4, s[32:35], s55 offen sc1
  s_add_u32 s55, s83, 327680
  buffer_store_dwordx4 v[132:135], v4, s[32:35], s55 offen sc1
  s_add_u32 s55, s83, 524288
  buffer_store_dwordx4 v[136:139], v4, s[32:35], s55 offen sc1
  s_add_u32 s55, s83, 589824
  buffer_store_dwordx4 v[140:143], v4, s[32:35], s55 offen sc1
L_aloop1:
  v_mov_b32 v104, 0
  s_mov_b32 s50, 0x400000
L_spin22:
  ds_read_b32 v105, v104
  s_waitcnt lgkmcnt(0)
  v_readfirstlane_b32 s51, v105
  s_sub_u32 s50, s50, 1
  s_cmp_ge_u32 s51, 8
  s_cbranch_scc1 L_spind23
  s_cmp_eq_u32 s50, 0
  s_cbranch_scc1 L_spind23
  s_sleep 1
  s_branch L_spin22
L_spind23:
  s_branch L_aloop4
L_aloop3:
  s_mov_b32 s73, 2
  s_cmp_ge_u32 s3, 4
  s_cbranch_scc1 L_aloop2
  s_waitcnt vmcnt(0)
  v_mov_b32 v104, 16
  v_mov_b32 v105, 1
  s_mov_b64 exec, 1
  ds_add_u32 v104, v105
  s_mov_b64 exec, -1
  s_branch L_aloop2
L_aloop4:
  s_cmp_lt_u32 s70, 16
  s_cbranch_scc1 L_aloop
  s_branch L_aloop3
L_aloop2:
  s_cmp_lt_u32 s70, 16
  s_cbranch_scc1 L_aloop
  s_waitcnt lgkmcnt(0)
  s_nop 7
  s_mov_b64 exec, 1
  ds_add_rtn_u32 v106, v146, v111
  s_mov_b64 exec, -1
  ds_read_b32 v148, v147
  ds_read_b128 v[56:59], v144
  ds_read_b128 v[60:63], v144 offset:1024
  ds_read_b128 v[64:67], v144 offset:2048
  ds_read_b128 v[68:71], v144 offset:3072
  ds_read_b32 v104, v145 offset:4096
  ds_read_b32 v105, v145 offset:4352
  s_waitcnt lgkmcnt(0)
  v_readfirstlane_b32 s55, v106
  v_readfirstlane_b32 s56, v148
  s_nop 3
  s_cmp_lg_u32 s55, 0
  s_cbranch_scc1 L_second
  v_mov_b32 v104, 20
  s_mov_b32 s50, 0x400000
L_spin24:
  ds_read_b32 v105, v104
  s_waitcnt lgkmcnt(0)
  v_readfirstlane_b32 s51, v105
  s_sub_u32 s50, s50, 1
  s_cmp_ge_u32 s51, 4
  s_cbranch_scc1 L_spind25
  s_cmp_eq_u32 s50, 0
  s_cbranch_scc1 L_spind25
  s_sleep 1
  s_branch L_spin24
L_spind25:
  ds_write_b128 v144, v[72:75]
  ds_write_b128 v144, v[76:79] offset:1024
  ds_write_b128 v144, v[88:91] offset:2048
  ds_write_b128 v144, v[92:95] offset:3072
  ds_write_b32 v145, v80 offset:4096
  ds_write_b32 v145, v96 offset:4352
  s_waitcnt lgkmcnt(0)
  v_mov_b32 v104, s76
  v_mov_b32 v105, 1
  s_mov_b64 exec, 1
  ds_add_u32 v104, v105
  s_mov_b64 exec, -1
  s_waitcnt lgkmcnt(0)
  s_endpgm
L_second:
  s_cmp_lg_u32 s56, 0
  s_cbranch_scc1 L_second2
  v_mov_b32 v104, s76
  s_mov_b32 s50, 0x400000
L_spin26:
  ds_read_b32 v105, v104
  s_waitcnt lgkmcnt(0)
  v_readfirstlane_b32 s51, v105
  s_sub_u32 s50, s50, 1
  s_cmp_ge_u32 s51, 1
  s_cbranch_scc1 L_spind27
  s_cmp_eq_u32 s50, 0
  s_cbranch_scc1 L_spind27
  s_sleep 1
  s_branch L_spin26
L_spind27:
  ds_read_b128 v[56:59], v144
  ds_read_b128 v[60:63], v144 offset:1024
  ds_read_b128 v[64:67], v144 offset:2048
  ds_read_b128 v[68:71], v144 offset:3072
  ds_read_b32 v104, v145 offset:4096
  ds_read_b32 v105, v145 offset:4352
  s_waitcnt lgkmcnt(0)
L_second2:
  v_add_f32 v72, v72, v56
  v_add_f32 v88, v88, v64
  v_add_f32 v73, v73, v57
  v_add_f32 v89, v89, v65
  v_add_f32 v74, v74, v58
  v_add_f32 v90, v90, v66
  v_add_f32 v75, v75, v59
  v_add_f32 v91, v91, v67
  v_add_f32 v76, v76, v60
  v_add_f32 v92, v92, v68
  v_add_f32 v77, v77, v61
  v_add_f32 v93, v93, v69
  v_add_f32 v78, v78, v62
  v_add_f32 v94, v94, v70
  v_add_f32 v79, v79, v63
  v_add_f32 v95, v95, v71
  v_add_f32 v80, v80, v104
  v_add_f32 v96, v96, v105
L_fin:
  v_mov_b32 v81, v80
  v_mov_b32 v97, v96
  s_nop 1
  v_permlane32_swap_b32 v81, v80
  v_permlane32_swap_b32 v97, v96
  s_nop 1
  v_rcp_f32 v82, v81
  v_rcp_f32 v98, v97
  s_add_u32 s32, s26, 14684160
  s_addc_u32 s33, s27, 0
  s_mov_b32 s34, 2097152
  s_mov_b32 s35, 0x20000
  s_lshl_b32 s54, s66, 5
  s_add_u32 s54, s54, s61
  s_lshl_b32 s55, s54, 10
  v_mul_f32 v40, v72, v82
  v_mul_f32 v41, v73, v82
  v_mul_f32 v42, v74, v82
  v_mul_f32 v43, v75, v82
  v_mul_f32 v44, v76, v82
  v_mul_f32 v45, v77, v82
  v_mul_f32 v46, v78, v82
  v_mul_f32 v47, v79, v82
  v_cvt_pk_bf16_f32 v56, v40, v41
  v_cvt_pk_bf16_f32 v57, v42, v43
  v_cvt_pk_bf16_f32 v58, v44, v45
  v_cvt_pk_bf16_f32 v59, v46, v47
  buffer_store_dwordx4 v[56:59], v4, s[32:35], s55 offen sc1
  s_add_u32 s55, s55, 32768
  v_mul_f32 v48, v88, v98
  v_mul_f32 v49, v89, v98
  v_mul_f32 v50, v90, v98
  v_mul_f32 v51, v91, v98
  v_mul_f32 v52, v92, v98
  v_mul_f32 v53, v93, v98
  v_mul_f32 v54, v94, v98
  v_mul_f32 v55, v95, v98
  v_cvt_pk_bf16_f32 v60, v48, v49
  v_cvt_pk_bf16_f32 v61, v50, v51
  v_cvt_pk_bf16_f32 v62, v52, v53
  v_cvt_pk_bf16_f32 v63, v54, v55
  buffer_store_dwordx4 v[60:63], v4, s[32:35], s55 offen sc1
  s_add_u32 s40, s26, 16785408
  s_addc_u32 s41, s27, 0
  s_mov_b32 s42, 16384
  s_mov_b32 s43, 0x20000
  v_mul_f32 v104, 0, v72
  v_fma_f32 v104, v73, 0, v104
  v_fma_f32 v104, v74, 0, v104
  v_fma_f32 v104, v75, 0, v104
  v_fma_f32 v104, v76, 0, v104
  v_fma_f32 v104, v77, 0, v104
  v_fma_f32 v104, v78, 0, v104
  v_fma_f32 v104, v79, 0, v104
  v_fma_f32 v104, v88, 0, v104
  v_fma_f32 v104, v89, 0, v104
  v_fma_f32 v104, v90, 0, v104
  v_fma_f32 v104, v91, 0, v104
  v_fma_f32 v104, v92, 0, v104
  v_fma_f32 v104, v93, 0, v104
  v_fma_f32 v104, v94, 0, v104
  v_fma_f32 v104, v95, 0, v104
  v_cmp_eq_f32 s[78:79], 0, v104
  s_mov_b32 s80, 0x21800000
  s_mov_b32 s81, 0x5d800000
  v_cmp_le_f32 s[82:83], s80, v81
  v_cmp_ge_f32 vcc, s81, v81
  s_nop 1
  s_and_b64 s[78:79], s[78:79], s[82:83]
  s_and_b64 s[78:79], s[78:79], vcc
  v_cmp_le_f32 s[82:83], s80, v97
  v_cmp_ge_f32 vcc, s81, v97
  s_nop 1
  s_and_b64 s[78:79], s[78:79], s[82:83]
  s_and_b64 s[78:79], s[78:79], vcc
  s_cmp_eq_u64 s[78:79], -1
  s_cbranch_scc1 L_ok
  s_cmp_eq_u32 s77, 0
  s_cbranch_scc1 L_slow
L_ok:
  v_mov_b32 v104, 24
  v_mov_b32 v105, 1
  s_mov_b64 exec, 1
  ds_add_u32 v104, v105
  s_mov_b64 exec, -1
  s_lshl_b32 s54, s54, 2
  s_add_u32 s54, s54, 8192
  v_mov_b32 v104, s60
  v_lshlrev_b32 v105, 7, v1
  s_waitcnt vmcnt(0)
  s_mov_b64 exec, 3
  buffer_store_dword v104, v105, s[40:43], s54 offen sc1
  s_mov_b64 exec, -1
  s_endpgm
L_slow:
  s_waitcnt vmcnt(0)
  s_mov_b32 s77, 1
  v_lshrrev_b32 v104, 5, v1
  v_and_b32 v105, 15, v1
  v_lshlrev_b32 v105, 4, v105
  v_lshl_add_u32 v106, v104, 8, v105
  v_add_u32 v106, 66560, v106
  v_mov_b32 v108, 0xff800000
  v_mov_b32 v109, 0xff800000
  v_add_u32 v104, 1024, v4
  s_mov_b32 s73, 0
L_slow1:
  ds_read_b128 v[16:19], v104
  s_waitcnt lgkmcnt(0)
  v_mfma_f32_32x32x16_bf16 v[40:55], v[16:19], v[8:11], 0
  v_mfma_f32_32x32x16_bf16 v[56:71], v[16:19], v[12:15], 0
  s_nop 15
  v_max3_f32 v108, v40, v41, v108
  v_max3_f32 v108, v42, v43, v108
  v_max3_f32 v108, v44, v45, v108
  v_max3_f32 v108, v46, v47, v108
  v_max3_f32 v108, v48, v49, v108
  v_max3_f32 v108, v50, v51, v108
  v_max3_f32 v108, v52, v53, v108
  v_max3_f32 v108, v54, v55, v108
  v_max3_f32 v109, v56, v57, v109
  v_max3_f32 v109, v58, v59, v109
  v_max3_f32 v109, v60, v61, v109
  v_max3_f32 v109, v62, v63, v109
  v_max3_f32 v109, v64, v65, v109
  v_max3_f32 v109, v66, v67, v109
  v_max3_f32 v109, v68, v69, v109
  v_max3_f32 v109, v70, v71, v109
  v_add_u32 v104, 1024, v104
  s_add_u32 s73, s73, 1
  s_cmp_lt_u32 s73, 64
  s_cbranch_scc1 L_slow1
  v_mov_b32 v105, v108
  s_nop 1
  v_permlane32_swap_b32 v105, v108
  s_nop 1
  v_max_f32 v108, v108, v105
  v_mov_b32 v105, v109
  s_nop 1
  v_permlane32_swap_b32 v105, v109
  s_nop 1
  v_max_f32 v109, v109, v105
  v_sub_f32 v112, 0, v108
  v_sub_f32 v113, 0, v108
  v_sub_f32 v114, 0, v108
  v_sub_f32 v115, 0, v108
  v_sub_f32 v116, 0, v108
  v_sub_f32 v117, 0, v108
  v_sub_f32 v118, 0, v108
  v_sub_f32 v119, 0, v108
  v_sub_f32 v120, 0, v108
  v_sub_f32 v121, 0, v108
  v_sub_f32 v122, 0, v108
  v_sub_f32 v123, 0, v108
  v_sub_f32 v124, 0, v108
  v_sub_f32 v125, 0, v108
  v_sub_f32 v126, 0, v108
  v_sub_f32 v127, 0, v108
  v_sub_f32 v128, 0, v109
  v_sub_f32 v129, 0, v109
  v_sub_f32 v130, 0, v109
  v_sub_f32 v131, 0, v109
  v_sub_f32 v132, 0, v109
  v_sub_f32 v133, 0, v109
  v_sub_f32 v134, 0, v109
  v_sub_f32 v135, 0, v109
  v_sub_f32 v136, 0, v109
  v_sub_f32 v137, 0, v109
  v_sub_f32 v138, 0, v109
  v_sub_f32 v139, 0, v109
  v_sub_f32 v140, 0, v109
  v_sub_f32 v141, 0, v109
  v_sub_f32 v142, 0, v109
  v_sub_f32 v143, 0, v109
  v_mov_b32 v72, 0
  v_mov_b32 v88, 0
  v_mov_b32 v73, 0
  v_mov_b32 v89, 0
  v_mov_b32 v74, 0
  v_mov_b32 v90, 0
  v_mov_b32 v75, 0
  v_mov_b32 v91, 0
  v_mov_b32 v76, 0
  v_mov_b32 v92, 0
  v_mov_b32 v77, 0
  v_mov_b32 v93, 0
  v_mov_b32 v78, 0
  v_mov_b32 v94, 0
  v_mov_b32 v79, 0
  v_mov_b32 v95, 0
  v_mov_b32 v80, 0
  v_mov_b32 v96, 0
  v_mov_b32 v81, 0
  v_mov_b32 v97, 0
  v_mov_b32 v82, 0
  v_mov_b32 v98, 0
  v_mov_b32 v83, 0
  v_mov_b32 v99, 0
  v_mov_b32 v84, 0
  v_mov_b32 v100, 0
  v_mov_b32 v85, 0
  v_mov_b32 v101, 0
  v_mov_b32 v86, 0
  v_mov_b32 v102, 0
  v_mov_b32 v87, 0
  v_mov_b32 v103, 0
  v_add_u32 v104, 1024, v4
  s_mov_b32 s73, 0
L_slow2:
  ds_read_b128 v[16:19], v104
  s_mov_b64 exec, s[74:75]
  ds_read_b128 v[24:27], v106
  ds_read_b128 v[28:31], v106 offset:512
  s_mov_b64 exec, -1
  s_waitcnt lgkmcnt(0)
  v_mfma_f32_32x32x16_bf16 v[40:55], v[16:19], v[8:11], v[112:127]
  v_mfma_f32_32x32x16_bf16 v[56:71], v[16:19], v[12:15], v[128:143]
  s_nop 15
  v_exp_f32 v40, v40
  v_exp_f32 v41, v41
  v_exp_f32 v42, v42
  v_exp_f32 v43, v43
  v_exp_f32 v44, v44
  v_exp_f32 v45, v45
  v_exp_f32 v46, v46
  v_exp_f32 v47, v47
  v_exp_f32 v48, v48
  v_exp_f32 v49, v49
  v_exp_f32 v50, v50
  v_exp_f32 v51, v51
  v_exp_f32 v52, v52
  v_exp_f32 v53, v53
  v_exp_f32 v54, v54
  v_exp_f32 v55, v55
  s_nop 0
  v_cvt_pk_bf16_f32 v40, v40, v41
  v_cvt_pk_bf16_f32 v41, v42, v43
  v_cvt_pk_bf16_f32 v42, v44, v45
  v_cvt_pk_bf16_f32 v43, v46, v47
  v_cvt_pk_bf16_f32 v44, v48, v49
  v_cvt_pk_bf16_f32 v45, v50, v51
  v_cvt_pk_bf16_f32 v46, v52, v53
  v_cvt_pk_bf16_f32 v47, v54, v55
  s_nop 1
  v_mfma_f32_32x32x16_bf16 v[72:87], v[24:27], v[40:43], v[72:87]
  v_mfma_f32_32x32x16_bf16 v[72:87], v[28:31], v[44:47], v[72:87]
  v_exp_f32 v56, v56
  v_exp_f32 v57, v57
  v_exp_f32 v58, v58
  v_exp_f32 v59, v59
  v_exp_f32 v60, v60
  v_exp_f32 v61, v61
  v_exp_f32 v62, v62
  v_exp_f32 v63, v63
  v_exp_f32 v64, v64
  v_exp_f32 v65, v65
  v_exp_f32 v66, v66
  v_exp_f32 v67, v67
  v_exp_f32 v68, v68
  v_exp_f32 v69, v69
  v_exp_f32 v70, v70
  v_exp_f32 v71, v71
  s_nop 0
  v_cvt_pk_bf16_f32 v56, v56, v57
  v_cvt_pk_bf16_f32 v57, v58, v59
  v_cvt_pk_bf16_f32 v58, v60, v61
  v_cvt_pk_bf16_f32 v59, v62, v63
  v_cvt_pk_bf16_f32 v60, v64, v65
  v_cvt_pk_bf16_f32 v61, v66, v67
  v_cvt_pk_bf16_f32 v62, v68, v69
  v_cvt_pk_bf16_f32 v63, v70, v71
  s_nop 1
  v_mfma_f32_32x32x16_bf16 v[88:103], v[24:27], v[56:59], v[88:103]
  v_mfma_f32_32x32x16_bf16 v[88:103], v[28:31], v[60:63], v[88:103]
  v_add_u32 v104, 1024, v104
  v_add_u32 v106, 1024, v106
  s_add_u32 s73, s73, 1
  s_cmp_lt_u32 s73, 64
  s_cbranch_scc1 L_slow2
  s_nop 15
  s_branch L_fin
L_end:
  s_endpgm
L_code_end:
  s_endpgm
.section .rodata,"a"
.p2align 6
.amdhsa_kernel gated_mix__mha_block__dense_activation_squared_relu__prompt_kernel
  .amdhsa_next_free_vgpr 168
  .amdhsa_next_free_sgpr 102
  .amdhsa_accum_offset 168
  .amdhsa_group_segment_fixed_size 0
  .amdhsa_kernarg_size 96
  .amdhsa_user_sgpr_count 2
  .amdhsa_user_sgpr_kernarg_segment_ptr 1
  .amdhsa_system_sgpr_workgroup_id_x 1
.end_amdhsa_kernel
```
